```python
import torch

def _softmax(x, axis=-1):
    return torch.softmax(x, dim=axis)
def _gelu(x):
    return torch.nn.functional.gelu(x, approximate="tanh")
def _silu(x):
    return torch.nn.functional.silu(x)
def _sigmoid(x):
    return torch.sigmoid(x)
def _layernorm(x, axis=-1, eps=1e-5):
    m = x.mean(dim=axis, keepdim=True)
    v = x.var(dim=axis, keepdim=True, unbiased=False)
    return (x - m) / torch.sqrt(v + eps)
def _scatter_add(tgt, idx, src, axis=0):
    return tgt.clone().index_add_(axis, idx, src)
def _segment_sum(src, seg, n):
    out = torch.zeros((n,) + src.shape[1:], dtype=src.dtype)
    return out.index_add_(0, seg, src)
def _pad(x, pw):
    flat = tuple(v for pair in reversed(pw) for v in pair)
    return torch.nn.functional.pad(x, flat)

kernel_name = 'recurrent_scan__gqa_block_cached__swiglu_ffn__decode'

def setup_inputs():

    _w = (lambda a: (lambda t: t.to(torch.bfloat16) if t.is_floating_point() else t)(torch.as_tensor(a)))
    def _A_setup():
        B, Sq, D = 1, 1, 576
        Hq, Hkv, Sk, Dh = 32, 16, 65536, 128
        assert Hq % Hkv == 0, (Hq, Hkv)
        return {
            "x": _w((lambda *s: torch.randn(*s, dtype=torch.bfloat16) * 0.05)(B, Sq, D)),
            "k_cache": _w((lambda *s: torch.randn(*s, dtype=torch.bfloat16) * 1.6)(B, Hkv, Sk, Dh)),
            "v_cache": _w((lambda *s: torch.randn(*s, dtype=torch.bfloat16) * 0.2)(B, Hkv, Sk, Dh)),
            "wq": _w((lambda *s: torch.randn(*s, dtype=torch.bfloat16) * 1.6)(D, Hq * Dh) * (D ** -0.5)),
            "wo": _w((lambda *s: torch.randn(*s, dtype=torch.bfloat16) * 0.2)(Hq * Dh, D) * ((Hq * Dh) ** -0.5)),
        }
    _A_in = _A_setup()

    def _B_setup():
        B, S, D, F = 1, 1, 576, 4608
        return {
            "x": _w((lambda *s: torch.randn(*s, dtype=torch.bfloat16) * 0.05)(B, S, D)),
            "w_gate": _w((lambda *s: torch.randn(*s, dtype=torch.bfloat16) * 0.1)(D, F)),
            "w_up": _w((lambda *s: torch.randn(*s, dtype=torch.bfloat16) * 0.1)(D, F)),
            "w_down": _w((lambda *s: torch.randn(*s, dtype=torch.bfloat16) * 0.1)(F, D)),
        }
    _B_in = _B_setup()

    return {
        "A_x": _A_in["x"],
        "A_k_cache": _A_in["k_cache"],
        "A_v_cache": _A_in["v_cache"],
        "A_wq": _A_in["wq"],
        "A_wo": _A_in["wo"],
        "B_x": _B_in["x"],
        "B_w_gate": _B_in["w_gate"],
        "B_w_up": _B_in["w_up"],
        "B_w_down": _B_in["w_down"],
    }

def reference(A_x, A_k_cache, A_v_cache, A_wq, A_wo, B_x, B_w_gate, B_w_up, B_w_down):
    def _A_ref(x, k_cache, v_cache, wq, wo):
        B, Sq, D = x.shape
        Hq, Dh = 32, 128
        Hkv = k_cache.shape[1]
        rep = Hq // Hkv
        q = (lambda x, *d: x.permute(*d))((x @ wq).reshape(B, Sq, Hq, Dh), 0, 2, 1, 3)
        k = (lambda x, n, axis: torch.repeat_interleave(x, n, dim=axis))(k_cache, rep, axis=1)
        v = (lambda x, n, axis: torch.repeat_interleave(x, n, dim=axis))(v_cache, rep, axis=1)
        scores = torch.einsum("bhqd,bhkd->bhqk", q, k) * (Dh ** -0.5)
        p = _softmax(scores, axis=-1)
        o = torch.einsum("bhqk,bhkd->bhqd", p, v)
        return (lambda x, *d: x.permute(*d))(o, 0, 2, 1, 3).reshape(B, Sq, Hq * Dh) @ wo

    def _B_ref(x, w_gate, w_up, w_down):
        g = _silu(x @ w_gate)
        u = x @ w_up
        return (g * u) @ w_down

    x = A_x
    xn = _layernorm(x, axis=-1)
    s = _A_ref(xn, A_k_cache, A_v_cache, A_wq, A_wo)
    g = _silu(_B_ref(xn, B_w_gate, B_w_up, B_w_down))
    return x + s * g
```

```asm
; @launch grid=(256,1,1) block=(512,1,1) lds=51200
.amdgcn_target "amdgcn-amd-amdhsa--gfx950"
.text
.globl recurrent_scan__gqa_block_cached__swiglu_ffn__decode_kernel
.p2align 8
.type recurrent_scan__gqa_block_cached__swiglu_ffn__decode_kernel,@function
recurrent_scan__gqa_block_cached__swiglu_ffn__decode_kernel:
    s_cmp_ge_u32 s2, 256
    s_cbranch_scc1 L_exit
    s_load_dwordx16 s[4:19], s[0:1], 0
    s_load_dwordx8 s[20:27], s[0:1], 64
    s_memrealtime s[94:95]
    v_and_b32 v1, 63, v0
    v_lshrrev_b32 v2, 6, v0
    s_lshr_b32 s72, s2, 4
    s_and_b32 s73, s2, 15
    v_readfirstlane_b32 s74, v2
    s_nop 0
    s_xor_b32 s74, s74, 4
    s_mov_b32 s75, s2
    s_lshr_b32 s100, s73, 2
    s_and_b32 s101, s73, 3
    s_mov_b32 s79, 0x3fb8aa3b
    v_mov_b32 v253, 0
    v_mov_b32 v255, 0
    s_waitcnt lgkmcnt(0)
    s_or_b32 s88, s94, 1
    s_mov_b32 s60, s26
    s_and_b32 s61, s27, 0xffff
    s_mov_b32 s62, 2496512
    s_mov_b32 s63, 0x20000
    s_cmp_ge_u32 s74, 4
    s_cbranch_scc1 L_helper
    s_mov_b32 s76, 0x05040100
    s_mov_b32 s77, 0x07060302
    s_mov_b32 s78, 0x3db504f3
    v_and_b32 v2, 3, v1
    v_lshlrev_b32 v2, 10, v2
    v_bfe_u32 v3, v1, 2, 2
    v_lshlrev_b32 v3, 8, v3
    v_lshrrev_b32 v4, 4, v1
    v_lshlrev_b32 v4, 4, v4
    v_add3_u32 v12, v2, v3, v4
    v_lshlrev_b32 v13, 4, v1
    s_lshl_b32 s82, s72, 24
    s_add_u32 s28, s6, s82
    s_addc_u32 s29, s7, 0
    s_and_b32 s29, s29, 0xffff
    s_mov_b32 s30, 16777216
    s_mov_b32 s31, 0x20000
    s_add_u32 s32, s8, s82
    s_addc_u32 s33, s9, 0
    s_and_b32 s33, s33, 0xffff
    s_mov_b32 s34, 16777216
    s_mov_b32 s35, 0x20000
    s_lshl_b32 s92, s73, 20
    s_lshl_b32 s82, s74, 12
    s_add_u32 s92, s92, s82
    s_lshl_b32 s82, s72, 7
    s_add_u32 s82, s82, 2494464
    s_add_u32 s38, s26, s82
    s_addc_u32 s39, s27, 0
    s_mov_b32 s36, 0
    s_mov_b32 s37, 0
    s_mov_b32 s40, 40
    s_mov_b32 s89, s92
    s_add_u32 s84, s92, 32768
    buffer_load_dwordx4 v[88:91], v12, s[28:31], s89 offen offset:0 nt
    buffer_load_dwordx4 v[92:95], v12, s[28:31], s89 offen offset:64 nt
    buffer_load_dwordx4 v[96:99], v12, s[28:31], s89 offen offset:128 nt
    buffer_load_dwordx4 v[100:103], v12, s[28:31], s89 offen offset:192 nt
    buffer_load_dwordx4 v[104:107], v12, s[28:31], s84 offen offset:0 nt
    buffer_load_dwordx4 v[108:111], v12, s[28:31], s84 offen offset:64 nt
    buffer_load_dwordx4 v[112:115], v12, s[28:31], s84 offen offset:128 nt
    buffer_load_dwordx4 v[116:119], v12, s[28:31], s84 offen offset:192 nt
    s_barrier
    buffer_load_dwordx4 v[152:155], v13, s[32:35], s89 offen offset:0 nt
    buffer_load_dwordx4 v[156:159], v13, s[32:35], s89 offen offset:1024 nt
    buffer_load_dwordx4 v[160:163], v13, s[32:35], s89 offen offset:2048 nt
    buffer_load_dwordx4 v[164:167], v13, s[32:35], s89 offen offset:3072 nt
    buffer_load_dwordx4 v[168:171], v13, s[32:35], s84 offen offset:0 nt
    buffer_load_dwordx4 v[172:175], v13, s[32:35], s84 offen offset:1024 nt
    buffer_load_dwordx4 v[176:179], v13, s[32:35], s84 offen offset:2048 nt
    buffer_load_dwordx4 v[180:183], v13, s[32:35], s84 offen offset:3072 nt
    s_add_u32 s92, s92, 65536
    s_mov_b32 s90, s92
    s_add_u32 s84, s92, 32768
    buffer_load_dwordx4 v[120:123], v12, s[28:31], s90 offen offset:0 nt
    buffer_load_dwordx4 v[124:127], v12, s[28:31], s90 offen offset:64 nt
    buffer_load_dwordx4 v[128:131], v12, s[28:31], s90 offen offset:128 nt
    buffer_load_dwordx4 v[132:135], v12, s[28:31], s90 offen offset:192 nt
    buffer_load_dwordx4 v[136:139], v12, s[28:31], s84 offen offset:0 nt
    buffer_load_dwordx4 v[140:143], v12, s[28:31], s84 offen offset:64 nt
    buffer_load_dwordx4 v[144:147], v12, s[28:31], s84 offen offset:128 nt
    buffer_load_dwordx4 v[148:151], v12, s[28:31], s84 offen offset:192 nt
    buffer_load_dwordx4 v[184:187], v13, s[32:35], s90 offen offset:0 nt
    buffer_load_dwordx4 v[188:191], v13, s[32:35], s90 offen offset:1024 nt
    buffer_load_dwordx4 v[192:195], v13, s[32:35], s90 offen offset:2048 nt
    buffer_load_dwordx4 v[196:199], v13, s[32:35], s90 offen offset:3072 nt
    buffer_load_dwordx4 v[200:203], v13, s[32:35], s84 offen offset:0 nt
    buffer_load_dwordx4 v[204:207], v13, s[32:35], s84 offen offset:1024 nt
    buffer_load_dwordx4 v[208:211], v13, s[32:35], s84 offen offset:2048 nt
    buffer_load_dwordx4 v[212:215], v13, s[32:35], s84 offen offset:3072 nt
    s_add_u32 s92, s92, 65536
    s_mov_b32 s93, 28
    s_mov_b32 s85, 1304347
L_sp1:
    ds_read_b32 v254, v253 offset:0
    s_waitcnt lgkmcnt(0)
    v_readfirstlane_b32 s82, v254
    s_cmp_ge_u32 s82, 1
    s_cbranch_scc1 L_spx2
    s_sub_u32 s85, s85, 1
    s_cmp_eq_u32 s85, 0
    s_cbranch_scc1 L_spx2
    s_sleep 1
    s_branch L_sp1
L_spx2:
    v_and_b32 v2, 1, v1
    v_lshlrev_b32 v2, 8, v2
    v_lshrrev_b32 v3, 4, v1
    v_lshl_add_u32 v2, v3, 4, v2
    ds_read_b128 v[20:23], v2 offset:3648
    ds_read_b128 v[24:27], v2 offset:3712
    ds_read_b128 v[28:31], v2 offset:3776
    ds_read_b128 v[32:35], v2 offset:3840
    v_mov_b32 v14, 0xff800000
    v_mov_b32 v16, 0xff800000
    v_mov_b32 v15, 0
    v_mov_b32 v36, 0
    v_mov_b32 v37, 0
    v_mov_b32 v38, 0
    v_mov_b32 v39, 0
    v_mov_b32 v40, 0
    v_mov_b32 v41, 0
    v_mov_b32 v42, 0
    v_mov_b32 v43, 0
    v_mov_b32 v44, 0
    v_mov_b32 v45, 0
    v_mov_b32 v46, 0
    v_mov_b32 v47, 0
    v_mov_b32 v48, 0
    v_mov_b32 v49, 0
    v_mov_b32 v50, 0
    v_mov_b32 v51, 0
    v_mov_b32 v52, 0
    v_mov_b32 v53, 0
    v_mov_b32 v54, 0
    v_mov_b32 v55, 0
    v_mov_b32 v56, 0
    v_mov_b32 v57, 0
    v_mov_b32 v58, 0
    v_mov_b32 v59, 0
    v_mov_b32 v60, 0
    v_mov_b32 v61, 0
    v_mov_b32 v62, 0
    v_mov_b32 v63, 0
    v_mov_b32 v64, 0
    v_mov_b32 v65, 0
    v_mov_b32 v66, 0
    v_mov_b32 v67, 0
    s_waitcnt lgkmcnt(0)
L_loop:
    s_cmp_ge_u32 s89, 1073741824
    s_cbranch_scc1 L_sdone
    s_waitcnt vmcnt(28)
    v_mfma_f32_16x16x32_bf16 v[68:71], v[88:91], v[20:23], 0
    v_mfma_f32_16x16x32_bf16 v[68:71], v[92:95], v[24:27], v[68:71]
    v_mfma_f32_16x16x32_bf16 v[68:71], v[96:99], v[28:31], v[68:71]
    v_mfma_f32_16x16x32_bf16 v[68:71], v[100:103], v[32:35], v[68:71]
    s_mov_b32 s91, s92
    s_cmp_gt_i32 s93, 0
    s_cbranch_scc1 L_ddn5
    s_mov_b32 s91, 1073741824
    s_cmp_lg_u32 s36, 0
    s_cbranch_scc1 L_ddn5
    v_mov_b32 v17, 1
    s_mov_b64 exec, 1
    ds_add_rtn_u32 v17, v253, v17 offset:44
    s_waitcnt lgkmcnt(0)
    v_readfirstlane_b32 s82, v17
    s_mov_b32 s85, 0x200000
L_dsp4:
    ds_read_b64 v[18:19], v253 offset:48
    s_waitcnt lgkmcnt(0)
    v_readfirstlane_b32 s81, v19
    v_readfirstlane_b32 s80, v18
    s_sub_u32 s85, s85, 1
    s_cmp_eq_u32 s85, 0
    s_cselect_b32 s81, 1, s81
    s_cmp_eq_u32 s81, 0
    s_cbranch_scc1 L_dsp4
    s_sub_u32 s81, s81, 1
    s_add_u32 s82, s82, s80
    s_cmp_ge_u32 s82, s81
    s_cbranch_scc1 L_dyn3
    s_lshr_b32 s80, s82, 3
    s_lshl_b32 s80, s80, 20
    s_and_b32 s81, s82, 7
    s_and_b32 s84, s81, 3
    s_lshr_b32 s81, s81, 2
    s_lshl_b32 s81, s81, 4
    s_add_u32 s81, s81, s84
    s_add_u32 s81, s81, 228
    s_lshl_b32 s81, s81, 12
    s_add_u32 s91, s80, s81
L_dyn3:
    s_mov_b64 exec, -1
    s_cmp_ge_u32 s91, 1073741824
    s_cselect_b32 s36, 1, 0
L_ddn5:
    s_cmp_eq_u32 s93, 15
    s_mov_b32 s82, 65536
    s_cselect_b32 s82, 4294000640, s82
    s_add_u32 s92, s92, s82
    s_sub_u32 s93, s93, 1
    s_add_u32 s84, s91, 32768
    s_waitcnt vmcnt(24)
    v_mfma_f32_16x16x32_bf16 v[72:75], v[104:107], v[20:23], 0
    v_mfma_f32_16x16x32_bf16 v[72:75], v[108:111], v[24:27], v[72:75]
    v_mfma_f32_16x16x32_bf16 v[72:75], v[112:115], v[28:31], v[72:75]
    v_mfma_f32_16x16x32_bf16 v[72:75], v[116:119], v[32:35], v[72:75]
    s_nop 3
    buffer_load_dwordx4 v[88:91], v12, s[28:31], s91 offen offset:0 nt
    buffer_load_dwordx4 v[92:95], v12, s[28:31], s91 offen offset:64 nt
    s_nop 2
    v_cvt_pk_bf16_f32 v2, v68, v69
    v_cvt_pk_bf16_f32 v3, v70, v71
    v_cvt_pk_bf16_f32 v4, v72, v73
    v_cvt_pk_bf16_f32 v5, v74, v75
    v_lshlrev_b32 v68, 16, v2
    v_and_b32 v69, 0xffff0000, v2
    v_lshlrev_b32 v70, 16, v3
    v_and_b32 v71, 0xffff0000, v3
    v_lshlrev_b32 v72, 16, v4
    v_and_b32 v73, 0xffff0000, v4
    v_lshlrev_b32 v74, 16, v5
    v_and_b32 v75, 0xffff0000, v5
    v_mul_f32 v68, s78, v68
    v_mul_f32 v69, s78, v69
    buffer_load_dwordx4 v[96:99], v12, s[28:31], s91 offen offset:128 nt
    v_mul_f32 v70, s78, v70
    v_mul_f32 v71, s78, v71
    v_mul_f32 v72, s78, v72
    v_mul_f32 v73, s78, v73
    v_mul_f32 v74, s78, v74
    v_mul_f32 v75, s78, v75
    v_cvt_pk_bf16_f32 v2, v68, v69
    v_cvt_pk_bf16_f32 v3, v70, v71
    v_cvt_pk_bf16_f32 v4, v72, v73
    v_cvt_pk_bf16_f32 v5, v74, v75
    v_lshlrev_b32 v68, 16, v2
    v_and_b32 v69, 0xffff0000, v2
    v_lshlrev_b32 v70, 16, v3
    v_and_b32 v71, 0xffff0000, v3
    buffer_load_dwordx4 v[100:103], v12, s[28:31], s91 offen offset:192 nt
    v_lshlrev_b32 v72, 16, v4
    v_and_b32 v73, 0xffff0000, v4
    v_lshlrev_b32 v74, 16, v5
    v_and_b32 v75, 0xffff0000, v5
    v_max3_f32 v6, v68, v69, v70
    v_max3_f32 v6, v6, v71, v72
    v_max3_f32 v6, v6, v73, v74
    v_max3_f32 v6, v6, v75, v14
    v_mov_b32 v7, v6
    s_nop 1
    v_permlane32_swap_b32 v6, v7
    s_nop 0
    v_max_f32 v6, v6, v7
    v_mov_b32 v7, v6
    buffer_load_dwordx4 v[104:107], v12, s[28:31], s84 offen offset:0 nt
    s_nop 1
    v_permlane16_swap_b32 v6, v7
    s_nop 0
    v_max_f32 v6, v6, v7
    v_mul_f32 v7, s79, v6
    v_sub_f32 v8, v16, v7
    v_exp_f32 v8, v8
    v_mov_b32 v14, v6
    v_mov_b32 v16, v7
    v_fma_f32 v68, v68, s79, -v16
    v_fma_f32 v69, v69, s79, -v16
    v_fma_f32 v70, v70, s79, -v16
    v_fma_f32 v71, v71, s79, -v16
    v_fma_f32 v72, v72, s79, -v16
    buffer_load_dwordx4 v[108:111], v12, s[28:31], s84 offen offset:64 nt
    v_fma_f32 v73, v73, s79, -v16
    v_fma_f32 v74, v74, s79, -v16
    v_fma_f32 v75, v75, s79, -v16
    v_exp_f32 v68, v68
    v_exp_f32 v69, v69
    v_exp_f32 v70, v70
    v_exp_f32 v71, v71
    v_exp_f32 v72, v72
    v_exp_f32 v73, v73
    v_exp_f32 v74, v74
    v_exp_f32 v75, v75
    v_readlane_b32 s80, v8, 0
    v_readlane_b32 s81, v8, 1
    v_mul_f32 v15, v15, v8
    buffer_load_dwordx4 v[112:115], v12, s[28:31], s84 offen offset:128 nt
    v_cvt_pk_bf16_f32 v76, v68, v69
    v_cvt_pk_bf16_f32 v77, v70, v71
    v_cvt_pk_bf16_f32 v78, v72, v73
    v_cvt_pk_bf16_f32 v79, v74, v75
    v_add_f32 v15, v15, v68
    v_add_f32 v15, v15, v69
    v_add_f32 v15, v15, v70
    v_add_f32 v15, v15, v71
    v_add_f32 v15, v15, v72
    v_add_f32 v15, v15, v73
    v_add_f32 v15, v15, v74
    v_add_f32 v15, v15, v75
    v_mul_f32 v36, s80, v36
    v_mul_f32 v37, s81, v37
    buffer_load_dwordx4 v[116:119], v12, s[28:31], s84 offen offset:192 nt
    v_mul_f32 v40, s80, v40
    v_mul_f32 v41, s81, v41
    v_mul_f32 v44, s80, v44
    v_mul_f32 v45, s81, v45
    v_mul_f32 v48, s80, v48
    v_mul_f32 v49, s81, v49
    v_mul_f32 v52, s80, v52
    v_mul_f32 v53, s81, v53
    v_mul_f32 v56, s80, v56
    v_mul_f32 v57, s81, v57
    v_mul_f32 v60, s80, v60
    v_mul_f32 v61, s81, v61
    v_mul_f32 v64, s80, v64
    v_mul_f32 v65, s81, v65
    s_waitcnt vmcnt(24)
    v_perm_b32 v80, v156, v152, s76
    v_perm_b32 v81, v164, v160, s76
    v_perm_b32 v82, v172, v168, s76
    v_perm_b32 v83, v180, v176, s76
    v_perm_b32 v84, v156, v152, s77
    v_perm_b32 v85, v164, v160, s77
    v_perm_b32 v86, v172, v168, s77
    v_perm_b32 v87, v180, v176, s77
    v_mfma_f32_16x16x32_bf16 v[36:39], v[76:79], v[80:83], v[36:39]
    buffer_load_dwordx4 v[216:219], v13, s[32:35], s91 offen offset:0 nt
    v_perm_b32 v80, v157, v153, s76
    v_perm_b32 v81, v165, v161, s76
    v_perm_b32 v82, v173, v169, s76
    v_perm_b32 v83, v181, v177, s76
    v_mfma_f32_16x16x32_bf16 v[40:43], v[76:79], v[84:87], v[40:43]
    buffer_load_dwordx4 v[220:223], v13, s[32:35], s91 offen offset:1024 nt
    v_perm_b32 v84, v157, v153, s77
    v_perm_b32 v85, v165, v161, s77
    v_perm_b32 v86, v173, v169, s77
    v_perm_b32 v87, v181, v177, s77
    v_mfma_f32_16x16x32_bf16 v[44:47], v[76:79], v[80:83], v[44:47]
    buffer_load_dwordx4 v[224:227], v13, s[32:35], s91 offen offset:2048 nt
    v_perm_b32 v80, v158, v154, s76
    v_perm_b32 v81, v166, v162, s76
    v_perm_b32 v82, v174, v170, s76
    v_perm_b32 v83, v182, v178, s76
    v_mfma_f32_16x16x32_bf16 v[48:51], v[76:79], v[84:87], v[48:51]
    buffer_load_dwordx4 v[228:231], v13, s[32:35], s91 offen offset:3072 nt
    v_perm_b32 v84, v158, v154, s77
    v_perm_b32 v85, v166, v162, s77
    v_perm_b32 v86, v174, v170, s77
    v_perm_b32 v87, v182, v178, s77
    v_mfma_f32_16x16x32_bf16 v[52:55], v[76:79], v[80:83], v[52:55]
    buffer_load_dwordx4 v[232:235], v13, s[32:35], s84 offen offset:0 nt
    v_perm_b32 v80, v159, v155, s76
    v_perm_b32 v81, v167, v163, s76
    v_perm_b32 v82, v175, v171, s76
    v_perm_b32 v83, v183, v179, s76
    v_mfma_f32_16x16x32_bf16 v[56:59], v[76:79], v[84:87], v[56:59]
    buffer_load_dwordx4 v[236:239], v13, s[32:35], s84 offen offset:1024 nt
    v_perm_b32 v84, v159, v155, s77
    v_perm_b32 v85, v167, v163, s77
    v_perm_b32 v86, v175, v171, s77
    v_perm_b32 v87, v183, v179, s77
    v_mfma_f32_16x16x32_bf16 v[60:63], v[76:79], v[80:83], v[60:63]
    buffer_load_dwordx4 v[240:243], v13, s[32:35], s84 offen offset:2048 nt
    s_nop 1
    v_mfma_f32_16x16x32_bf16 v[64:67], v[76:79], v[84:87], v[64:67]
    buffer_load_dwordx4 v[244:247], v13, s[32:35], s84 offen offset:3072 nt
    s_cmp_ge_u32 s90, 1073741824
    s_cbranch_scc1 L_sdone
    s_waitcnt vmcnt(28)
    v_mfma_f32_16x16x32_bf16 v[68:71], v[120:123], v[20:23], 0
    v_mfma_f32_16x16x32_bf16 v[68:71], v[124:127], v[24:27], v[68:71]
    v_mfma_f32_16x16x32_bf16 v[68:71], v[128:131], v[28:31], v[68:71]
    v_mfma_f32_16x16x32_bf16 v[68:71], v[132:135], v[32:35], v[68:71]
    s_mov_b32 s89, s92
    s_cmp_gt_i32 s93, 0
    s_cbranch_scc1 L_ddn8
    s_mov_b32 s89, 1073741824
    s_cmp_lg_u32 s36, 0
    s_cbranch_scc1 L_ddn8
    v_mov_b32 v17, 1
    s_mov_b64 exec, 1
    ds_add_rtn_u32 v17, v253, v17 offset:44
    s_waitcnt lgkmcnt(0)
    v_readfirstlane_b32 s82, v17
    s_mov_b32 s85, 0x200000
L_dsp7:
    ds_read_b64 v[18:19], v253 offset:48
    s_waitcnt lgkmcnt(0)
    v_readfirstlane_b32 s81, v19
    v_readfirstlane_b32 s80, v18
    s_sub_u32 s85, s85, 1
    s_cmp_eq_u32 s85, 0
    s_cselect_b32 s81, 1, s81
    s_cmp_eq_u32 s81, 0
    s_cbranch_scc1 L_dsp7
    s_sub_u32 s81, s81, 1
    s_add_u32 s82, s82, s80
    s_cmp_ge_u32 s82, s81
    s_cbranch_scc1 L_dyn6
    s_lshr_b32 s80, s82, 3
    s_lshl_b32 s80, s80, 20
    s_and_b32 s81, s82, 7
    s_and_b32 s84, s81, 3
    s_lshr_b32 s81, s81, 2
    s_lshl_b32 s81, s81, 4
    s_add_u32 s81, s81, s84
    s_add_u32 s81, s81, 228
    s_lshl_b32 s81, s81, 12
    s_add_u32 s89, s80, s81
L_dyn6:
    s_mov_b64 exec, -1
    s_cmp_ge_u32 s89, 1073741824
    s_cselect_b32 s36, 1, 0
L_ddn8:
    s_cmp_eq_u32 s93, 15
    s_mov_b32 s82, 65536
    s_cselect_b32 s82, 4294000640, s82
    s_add_u32 s92, s92, s82
    s_sub_u32 s93, s93, 1
    s_add_u32 s84, s89, 32768
    s_waitcnt vmcnt(24)
    v_mfma_f32_16x16x32_bf16 v[72:75], v[136:139], v[20:23], 0
    v_mfma_f32_16x16x32_bf16 v[72:75], v[140:143], v[24:27], v[72:75]
    v_mfma_f32_16x16x32_bf16 v[72:75], v[144:147], v[28:31], v[72:75]
    v_mfma_f32_16x16x32_bf16 v[72:75], v[148:151], v[32:35], v[72:75]
    s_nop 3
    buffer_load_dwordx4 v[120:123], v12, s[28:31], s89 offen offset:0 nt
    buffer_load_dwordx4 v[124:127], v12, s[28:31], s89 offen offset:64 nt
    s_nop 2
    v_cvt_pk_bf16_f32 v2, v68, v69
    v_cvt_pk_bf16_f32 v3, v70, v71
    v_cvt_pk_bf16_f32 v4, v72, v73
    v_cvt_pk_bf16_f32 v5, v74, v75
    v_lshlrev_b32 v68, 16, v2
    v_and_b32 v69, 0xffff0000, v2
    v_lshlrev_b32 v70, 16, v3
    v_and_b32 v71, 0xffff0000, v3
    v_lshlrev_b32 v72, 16, v4
    v_and_b32 v73, 0xffff0000, v4
    v_lshlrev_b32 v74, 16, v5
    v_and_b32 v75, 0xffff0000, v5
    v_mul_f32 v68, s78, v68
    v_mul_f32 v69, s78, v69
    buffer_load_dwordx4 v[128:131], v12, s[28:31], s89 offen offset:128 nt
    v_mul_f32 v70, s78, v70
    v_mul_f32 v71, s78, v71
    v_mul_f32 v72, s78, v72
    v_mul_f32 v73, s78, v73
    v_mul_f32 v74, s78, v74
    v_mul_f32 v75, s78, v75
    v_cvt_pk_bf16_f32 v2, v68, v69
    v_cvt_pk_bf16_f32 v3, v70, v71
    v_cvt_pk_bf16_f32 v4, v72, v73
    v_cvt_pk_bf16_f32 v5, v74, v75
    v_lshlrev_b32 v68, 16, v2
    v_and_b32 v69, 0xffff0000, v2
    v_lshlrev_b32 v70, 16, v3
    v_and_b32 v71, 0xffff0000, v3
    buffer_load_dwordx4 v[132:135], v12, s[28:31], s89 offen offset:192 nt
    v_lshlrev_b32 v72, 16, v4
    v_and_b32 v73, 0xffff0000, v4
    v_lshlrev_b32 v74, 16, v5
    v_and_b32 v75, 0xffff0000, v5
    v_max3_f32 v6, v68, v69, v70
    v_max3_f32 v6, v6, v71, v72
    v_max3_f32 v6, v6, v73, v74
    v_max3_f32 v6, v6, v75, v14
    v_mov_b32 v7, v6
    s_nop 1
    v_permlane32_swap_b32 v6, v7
    s_nop 0
    v_max_f32 v6, v6, v7
    v_mov_b32 v7, v6
    buffer_load_dwordx4 v[136:139], v12, s[28:31], s84 offen offset:0 nt
    s_nop 1
    v_permlane16_swap_b32 v6, v7
    s_nop 0
    v_max_f32 v6, v6, v7
    v_mul_f32 v7, s79, v6
    v_sub_f32 v8, v16, v7
    v_exp_f32 v8, v8
    v_mov_b32 v14, v6
    v_mov_b32 v16, v7
    v_fma_f32 v68, v68, s79, -v16
    v_fma_f32 v69, v69, s79, -v16
    v_fma_f32 v70, v70, s79, -v16
    v_fma_f32 v71, v71, s79, -v16
    v_fma_f32 v72, v72, s79, -v16
    buffer_load_dwordx4 v[140:143], v12, s[28:31], s84 offen offset:64 nt
    v_fma_f32 v73, v73, s79, -v16
    v_fma_f32 v74, v74, s79, -v16
    v_fma_f32 v75, v75, s79, -v16
    v_exp_f32 v68, v68
    v_exp_f32 v69, v69
    v_exp_f32 v70, v70
    v_exp_f32 v71, v71
    v_exp_f32 v72, v72
    v_exp_f32 v73, v73
    v_exp_f32 v74, v74
    v_exp_f32 v75, v75
    v_readlane_b32 s80, v8, 0
    v_readlane_b32 s81, v8, 1
    v_mul_f32 v15, v15, v8
    buffer_load_dwordx4 v[144:147], v12, s[28:31], s84 offen offset:128 nt
    v_cvt_pk_bf16_f32 v76, v68, v69
    v_cvt_pk_bf16_f32 v77, v70, v71
    v_cvt_pk_bf16_f32 v78, v72, v73
    v_cvt_pk_bf16_f32 v79, v74, v75
    v_add_f32 v15, v15, v68
    v_add_f32 v15, v15, v69
    v_add_f32 v15, v15, v70
    v_add_f32 v15, v15, v71
    v_add_f32 v15, v15, v72
    v_add_f32 v15, v15, v73
    v_add_f32 v15, v15, v74
    v_add_f32 v15, v15, v75
    v_mul_f32 v36, s80, v36
    v_mul_f32 v37, s81, v37
    buffer_load_dwordx4 v[148:151], v12, s[28:31], s84 offen offset:192 nt
    v_mul_f32 v40, s80, v40
    v_mul_f32 v41, s81, v41
    v_mul_f32 v44, s80, v44
    v_mul_f32 v45, s81, v45
    v_mul_f32 v48, s80, v48
    v_mul_f32 v49, s81, v49
    v_mul_f32 v52, s80, v52
    v_mul_f32 v53, s81, v53
    v_mul_f32 v56, s80, v56
    v_mul_f32 v57, s81, v57
    v_mul_f32 v60, s80, v60
    v_mul_f32 v61, s81, v61
    v_mul_f32 v64, s80, v64
    v_mul_f32 v65, s81, v65
    s_waitcnt vmcnt(24)
    v_perm_b32 v80, v188, v184, s76
    v_perm_b32 v81, v196, v192, s76
    v_perm_b32 v82, v204, v200, s76
    v_perm_b32 v83, v212, v208, s76
    v_perm_b32 v84, v188, v184, s77
    v_perm_b32 v85, v196, v192, s77
    v_perm_b32 v86, v204, v200, s77
    v_perm_b32 v87, v212, v208, s77
    v_mfma_f32_16x16x32_bf16 v[36:39], v[76:79], v[80:83], v[36:39]
    buffer_load_dwordx4 v[152:155], v13, s[32:35], s89 offen offset:0 nt
    v_perm_b32 v80, v189, v185, s76
    v_perm_b32 v81, v197, v193, s76
    v_perm_b32 v82, v205, v201, s76
    v_perm_b32 v83, v213, v209, s76
    v_mfma_f32_16x16x32_bf16 v[40:43], v[76:79], v[84:87], v[40:43]
    buffer_load_dwordx4 v[156:159], v13, s[32:35], s89 offen offset:1024 nt
    v_perm_b32 v84, v189, v185, s77
    v_perm_b32 v85, v197, v193, s77
    v_perm_b32 v86, v205, v201, s77
    v_perm_b32 v87, v213, v209, s77
    v_mfma_f32_16x16x32_bf16 v[44:47], v[76:79], v[80:83], v[44:47]
    buffer_load_dwordx4 v[160:163], v13, s[32:35], s89 offen offset:2048 nt
    v_perm_b32 v80, v190, v186, s76
    v_perm_b32 v81, v198, v194, s76
    v_perm_b32 v82, v206, v202, s76
    v_perm_b32 v83, v214, v210, s76
    v_mfma_f32_16x16x32_bf16 v[48:51], v[76:79], v[84:87], v[48:51]
    buffer_load_dwordx4 v[164:167], v13, s[32:35], s89 offen offset:3072 nt
    v_perm_b32 v84, v190, v186, s77
    v_perm_b32 v85, v198, v194, s77
    v_perm_b32 v86, v206, v202, s77
    v_perm_b32 v87, v214, v210, s77
    v_mfma_f32_16x16x32_bf16 v[52:55], v[76:79], v[80:83], v[52:55]
    buffer_load_dwordx4 v[168:171], v13, s[32:35], s84 offen offset:0 nt
    v_perm_b32 v80, v191, v187, s76
    v_perm_b32 v81, v199, v195, s76
    v_perm_b32 v82, v207, v203, s76
    v_perm_b32 v83, v215, v211, s76
    v_mfma_f32_16x16x32_bf16 v[56:59], v[76:79], v[84:87], v[56:59]
    buffer_load_dwordx4 v[172:175], v13, s[32:35], s84 offen offset:1024 nt
    v_perm_b32 v84, v191, v187, s77
    v_perm_b32 v85, v199, v195, s77
    v_perm_b32 v86, v207, v203, s77
    v_perm_b32 v87, v215, v211, s77
    v_mfma_f32_16x16x32_bf16 v[60:63], v[76:79], v[80:83], v[60:63]
    buffer_load_dwordx4 v[176:179], v13, s[32:35], s84 offen offset:2048 nt
    s_nop 1
    v_mfma_f32_16x16x32_bf16 v[64:67], v[76:79], v[84:87], v[64:67]
    buffer_load_dwordx4 v[180:183], v13, s[32:35], s84 offen offset:3072 nt
    s_cmp_ge_u32 s91, 1073741824
    s_cbranch_scc1 L_sdone
    s_waitcnt vmcnt(28)
    v_mfma_f32_16x16x32_bf16 v[68:71], v[88:91], v[20:23], 0
    v_mfma_f32_16x16x32_bf16 v[68:71], v[92:95], v[24:27], v[68:71]
    v_mfma_f32_16x16x32_bf16 v[68:71], v[96:99], v[28:31], v[68:71]
    v_mfma_f32_16x16x32_bf16 v[68:71], v[100:103], v[32:35], v[68:71]
    s_mov_b32 s90, s92
    s_cmp_gt_i32 s93, 0
    s_cbranch_scc1 L_ddn11
    s_mov_b32 s90, 1073741824
    s_cmp_lg_u32 s36, 0
    s_cbranch_scc1 L_ddn11
    v_mov_b32 v17, 1
    s_mov_b64 exec, 1
    ds_add_rtn_u32 v17, v253, v17 offset:44
    s_waitcnt lgkmcnt(0)
    v_readfirstlane_b32 s82, v17
    s_mov_b32 s85, 0x200000
L_dsp10:
    ds_read_b64 v[18:19], v253 offset:48
    s_waitcnt lgkmcnt(0)
    v_readfirstlane_b32 s81, v19
    v_readfirstlane_b32 s80, v18
    s_sub_u32 s85, s85, 1
    s_cmp_eq_u32 s85, 0
    s_cselect_b32 s81, 1, s81
    s_cmp_eq_u32 s81, 0
    s_cbranch_scc1 L_dsp10
    s_sub_u32 s81, s81, 1
    s_add_u32 s82, s82, s80
    s_cmp_ge_u32 s82, s81
    s_cbranch_scc1 L_dyn9
    s_lshr_b32 s80, s82, 3
    s_lshl_b32 s80, s80, 20
    s_and_b32 s81, s82, 7
    s_and_b32 s84, s81, 3
    s_lshr_b32 s81, s81, 2
    s_lshl_b32 s81, s81, 4
    s_add_u32 s81, s81, s84
    s_add_u32 s81, s81, 228
    s_lshl_b32 s81, s81, 12
    s_add_u32 s90, s80, s81
L_dyn9:
    s_mov_b64 exec, -1
    s_cmp_ge_u32 s90, 1073741824
    s_cselect_b32 s36, 1, 0
L_ddn11:
    s_cmp_eq_u32 s93, 15
    s_mov_b32 s82, 65536
    s_cselect_b32 s82, 4294000640, s82
    s_add_u32 s92, s92, s82
    s_sub_u32 s93, s93, 1
    s_add_u32 s84, s90, 32768
    s_waitcnt vmcnt(24)
    v_mfma_f32_16x16x32_bf16 v[72:75], v[104:107], v[20:23], 0
    v_mfma_f32_16x16x32_bf16 v[72:75], v[108:111], v[24:27], v[72:75]
    v_mfma_f32_16x16x32_bf16 v[72:75], v[112:115], v[28:31], v[72:75]
    v_mfma_f32_16x16x32_bf16 v[72:75], v[116:119], v[32:35], v[72:75]
    s_nop 3
    buffer_load_dwordx4 v[88:91], v12, s[28:31], s90 offen offset:0 nt
    buffer_load_dwordx4 v[92:95], v12, s[28:31], s90 offen offset:64 nt
    s_nop 2
    v_cvt_pk_bf16_f32 v2, v68, v69
    v_cvt_pk_bf16_f32 v3, v70, v71
    v_cvt_pk_bf16_f32 v4, v72, v73
    v_cvt_pk_bf16_f32 v5, v74, v75
    v_lshlrev_b32 v68, 16, v2
    v_and_b32 v69, 0xffff0000, v2
    v_lshlrev_b32 v70, 16, v3
    v_and_b32 v71, 0xffff0000, v3
    v_lshlrev_b32 v72, 16, v4
    v_and_b32 v73, 0xffff0000, v4
    v_lshlrev_b32 v74, 16, v5
    v_and_b32 v75, 0xffff0000, v5
    v_mul_f32 v68, s78, v68
    v_mul_f32 v69, s78, v69
    buffer_load_dwordx4 v[96:99], v12, s[28:31], s90 offen offset:128 nt
    v_mul_f32 v70, s78, v70
    v_mul_f32 v71, s78, v71
    v_mul_f32 v72, s78, v72
    v_mul_f32 v73, s78, v73
    v_mul_f32 v74, s78, v74
    v_mul_f32 v75, s78, v75
    v_cvt_pk_bf16_f32 v2, v68, v69
    v_cvt_pk_bf16_f32 v3, v70, v71
    v_cvt_pk_bf16_f32 v4, v72, v73
    v_cvt_pk_bf16_f32 v5, v74, v75
    v_lshlrev_b32 v68, 16, v2
    v_and_b32 v69, 0xffff0000, v2
    v_lshlrev_b32 v70, 16, v3
    v_and_b32 v71, 0xffff0000, v3
    buffer_load_dwordx4 v[100:103], v12, s[28:31], s90 offen offset:192 nt
    v_lshlrev_b32 v72, 16, v4
    v_and_b32 v73, 0xffff0000, v4
    v_lshlrev_b32 v74, 16, v5
    v_and_b32 v75, 0xffff0000, v5
    v_max3_f32 v6, v68, v69, v70
    v_max3_f32 v6, v6, v71, v72
    v_max3_f32 v6, v6, v73, v74
    v_max3_f32 v6, v6, v75, v14
    v_mov_b32 v7, v6
    s_nop 1
    v_permlane32_swap_b32 v6, v7
    s_nop 0
    v_max_f32 v6, v6, v7
    v_mov_b32 v7, v6
    buffer_load_dwordx4 v[104:107], v12, s[28:31], s84 offen offset:0 nt
    s_nop 1
    v_permlane16_swap_b32 v6, v7
    s_nop 0
    v_max_f32 v6, v6, v7
    v_mul_f32 v7, s79, v6
    v_sub_f32 v8, v16, v7
    v_exp_f32 v8, v8
    v_mov_b32 v14, v6
    v_mov_b32 v16, v7
    v_fma_f32 v68, v68, s79, -v16
    v_fma_f32 v69, v69, s79, -v16
    v_fma_f32 v70, v70, s79, -v16
    v_fma_f32 v71, v71, s79, -v16
    v_fma_f32 v72, v72, s79, -v16
    buffer_load_dwordx4 v[108:111], v12, s[28:31], s84 offen offset:64 nt
    v_fma_f32 v73, v73, s79, -v16
    v_fma_f32 v74, v74, s79, -v16
    v_fma_f32 v75, v75, s79, -v16
    v_exp_f32 v68, v68
    v_exp_f32 v69, v69
    v_exp_f32 v70, v70
    v_exp_f32 v71, v71
    v_exp_f32 v72, v72
    v_exp_f32 v73, v73
    v_exp_f32 v74, v74
    v_exp_f32 v75, v75
    v_readlane_b32 s80, v8, 0
    v_readlane_b32 s81, v8, 1
    v_mul_f32 v15, v15, v8
    buffer_load_dwordx4 v[112:115], v12, s[28:31], s84 offen offset:128 nt
    v_cvt_pk_bf16_f32 v76, v68, v69
    v_cvt_pk_bf16_f32 v77, v70, v71
    v_cvt_pk_bf16_f32 v78, v72, v73
    v_cvt_pk_bf16_f32 v79, v74, v75
    v_add_f32 v15, v15, v68
    v_add_f32 v15, v15, v69
    v_add_f32 v15, v15, v70
    v_add_f32 v15, v15, v71
    v_add_f32 v15, v15, v72
    v_add_f32 v15, v15, v73
    v_add_f32 v15, v15, v74
    v_add_f32 v15, v15, v75
    v_mul_f32 v36, s80, v36
    v_mul_f32 v37, s81, v37
    buffer_load_dwordx4 v[116:119], v12, s[28:31], s84 offen offset:192 nt
    v_mul_f32 v40, s80, v40
    v_mul_f32 v41, s81, v41
    v_mul_f32 v44, s80, v44
    v_mul_f32 v45, s81, v45
    v_mul_f32 v48, s80, v48
    v_mul_f32 v49, s81, v49
    v_mul_f32 v52, s80, v52
    v_mul_f32 v53, s81, v53
    v_mul_f32 v56, s80, v56
    v_mul_f32 v57, s81, v57
    v_mul_f32 v60, s80, v60
    v_mul_f32 v61, s81, v61
    v_mul_f32 v64, s80, v64
    v_mul_f32 v65, s81, v65
    s_waitcnt vmcnt(24)
    v_perm_b32 v80, v220, v216, s76
    v_perm_b32 v81, v228, v224, s76
    v_perm_b32 v82, v236, v232, s76
    v_perm_b32 v83, v244, v240, s76
    v_perm_b32 v84, v220, v216, s77
    v_perm_b32 v85, v228, v224, s77
    v_perm_b32 v86, v236, v232, s77
    v_perm_b32 v87, v244, v240, s77
    v_mfma_f32_16x16x32_bf16 v[36:39], v[76:79], v[80:83], v[36:39]
    buffer_load_dwordx4 v[184:187], v13, s[32:35], s90 offen offset:0 nt
    v_perm_b32 v80, v221, v217, s76
    v_perm_b32 v81, v229, v225, s76
    v_perm_b32 v82, v237, v233, s76
    v_perm_b32 v83, v245, v241, s76
    v_mfma_f32_16x16x32_bf16 v[40:43], v[76:79], v[84:87], v[40:43]
    buffer_load_dwordx4 v[188:191], v13, s[32:35], s90 offen offset:1024 nt
    v_perm_b32 v84, v221, v217, s77
    v_perm_b32 v85, v229, v225, s77
    v_perm_b32 v86, v237, v233, s77
    v_perm_b32 v87, v245, v241, s77
    v_mfma_f32_16x16x32_bf16 v[44:47], v[76:79], v[80:83], v[44:47]
    buffer_load_dwordx4 v[192:195], v13, s[32:35], s90 offen offset:2048 nt
    v_perm_b32 v80, v222, v218, s76
    v_perm_b32 v81, v230, v226, s76
    v_perm_b32 v82, v238, v234, s76
    v_perm_b32 v83, v246, v242, s76
    v_mfma_f32_16x16x32_bf16 v[48:51], v[76:79], v[84:87], v[48:51]
    buffer_load_dwordx4 v[196:199], v13, s[32:35], s90 offen offset:3072 nt
    v_perm_b32 v84, v222, v218, s77
    v_perm_b32 v85, v230, v226, s77
    v_perm_b32 v86, v238, v234, s77
    v_perm_b32 v87, v246, v242, s77
    v_mfma_f32_16x16x32_bf16 v[52:55], v[76:79], v[80:83], v[52:55]
    buffer_load_dwordx4 v[200:203], v13, s[32:35], s84 offen offset:0 nt
    v_perm_b32 v80, v223, v219, s76
    v_perm_b32 v81, v231, v227, s76
    v_perm_b32 v82, v239, v235, s76
    v_perm_b32 v83, v247, v243, s76
    v_mfma_f32_16x16x32_bf16 v[56:59], v[76:79], v[84:87], v[56:59]
    buffer_load_dwordx4 v[204:207], v13, s[32:35], s84 offen offset:1024 nt
    v_perm_b32 v84, v223, v219, s77
    v_perm_b32 v85, v231, v227, s77
    v_perm_b32 v86, v239, v235, s77
    v_perm_b32 v87, v247, v243, s77
    v_mfma_f32_16x16x32_bf16 v[60:63], v[76:79], v[80:83], v[60:63]
    buffer_load_dwordx4 v[208:211], v13, s[32:35], s84 offen offset:2048 nt
    s_nop 1
    v_mfma_f32_16x16x32_bf16 v[64:67], v[76:79], v[84:87], v[64:67]
    buffer_load_dwordx4 v[212:215], v13, s[32:35], s84 offen offset:3072 nt
    s_cmp_ge_u32 s89, 1073741824
    s_cbranch_scc1 L_sdone
    s_waitcnt vmcnt(28)
    v_mfma_f32_16x16x32_bf16 v[68:71], v[120:123], v[20:23], 0
    v_mfma_f32_16x16x32_bf16 v[68:71], v[124:127], v[24:27], v[68:71]
    v_mfma_f32_16x16x32_bf16 v[68:71], v[128:131], v[28:31], v[68:71]
    v_mfma_f32_16x16x32_bf16 v[68:71], v[132:135], v[32:35], v[68:71]
    s_mov_b32 s91, s92
    s_cmp_gt_i32 s93, 0
    s_cbranch_scc1 L_ddn14
    s_mov_b32 s91, 1073741824
    s_cmp_lg_u32 s36, 0
    s_cbranch_scc1 L_ddn14
    v_mov_b32 v17, 1
    s_mov_b64 exec, 1
    ds_add_rtn_u32 v17, v253, v17 offset:44
    s_waitcnt lgkmcnt(0)
    v_readfirstlane_b32 s82, v17
    s_mov_b32 s85, 0x200000
L_dsp13:
    ds_read_b64 v[18:19], v253 offset:48
    s_waitcnt lgkmcnt(0)
    v_readfirstlane_b32 s81, v19
    v_readfirstlane_b32 s80, v18
    s_sub_u32 s85, s85, 1
    s_cmp_eq_u32 s85, 0
    s_cselect_b32 s81, 1, s81
    s_cmp_eq_u32 s81, 0
    s_cbranch_scc1 L_dsp13
    s_sub_u32 s81, s81, 1
    s_add_u32 s82, s82, s80
    s_cmp_ge_u32 s82, s81
    s_cbranch_scc1 L_dyn12
    s_lshr_b32 s80, s82, 3
    s_lshl_b32 s80, s80, 20
    s_and_b32 s81, s82, 7
    s_and_b32 s84, s81, 3
    s_lshr_b32 s81, s81, 2
    s_lshl_b32 s81, s81, 4
    s_add_u32 s81, s81, s84
    s_add_u32 s81, s81, 228
    s_lshl_b32 s81, s81, 12
    s_add_u32 s91, s80, s81
L_dyn12:
    s_mov_b64 exec, -1
    s_cmp_ge_u32 s91, 1073741824
    s_cselect_b32 s36, 1, 0
L_ddn14:
    s_cmp_eq_u32 s93, 15
    s_mov_b32 s82, 65536
    s_cselect_b32 s82, 4294000640, s82
    s_add_u32 s92, s92, s82
    s_sub_u32 s93, s93, 1
    s_add_u32 s84, s91, 32768
    s_waitcnt vmcnt(24)
    v_mfma_f32_16x16x32_bf16 v[72:75], v[136:139], v[20:23], 0
    v_mfma_f32_16x16x32_bf16 v[72:75], v[140:143], v[24:27], v[72:75]
    v_mfma_f32_16x16x32_bf16 v[72:75], v[144:147], v[28:31], v[72:75]
    v_mfma_f32_16x16x32_bf16 v[72:75], v[148:151], v[32:35], v[72:75]
    s_nop 3
    buffer_load_dwordx4 v[120:123], v12, s[28:31], s91 offen offset:0 nt
    buffer_load_dwordx4 v[124:127], v12, s[28:31], s91 offen offset:64 nt
    s_nop 2
    v_cvt_pk_bf16_f32 v2, v68, v69
    v_cvt_pk_bf16_f32 v3, v70, v71
    v_cvt_pk_bf16_f32 v4, v72, v73
    v_cvt_pk_bf16_f32 v5, v74, v75
    v_lshlrev_b32 v68, 16, v2
    v_and_b32 v69, 0xffff0000, v2
    v_lshlrev_b32 v70, 16, v3
    v_and_b32 v71, 0xffff0000, v3
    v_lshlrev_b32 v72, 16, v4
    v_and_b32 v73, 0xffff0000, v4
    v_lshlrev_b32 v74, 16, v5
    v_and_b32 v75, 0xffff0000, v5
    v_mul_f32 v68, s78, v68
    v_mul_f32 v69, s78, v69
    buffer_load_dwordx4 v[128:131], v12, s[28:31], s91 offen offset:128 nt
    v_mul_f32 v70, s78, v70
    v_mul_f32 v71, s78, v71
    v_mul_f32 v72, s78, v72
    v_mul_f32 v73, s78, v73
    v_mul_f32 v74, s78, v74
    v_mul_f32 v75, s78, v75
    v_cvt_pk_bf16_f32 v2, v68, v69
    v_cvt_pk_bf16_f32 v3, v70, v71
    v_cvt_pk_bf16_f32 v4, v72, v73
    v_cvt_pk_bf16_f32 v5, v74, v75
    v_lshlrev_b32 v68, 16, v2
    v_and_b32 v69, 0xffff0000, v2
    v_lshlrev_b32 v70, 16, v3
    v_and_b32 v71, 0xffff0000, v3
    buffer_load_dwordx4 v[132:135], v12, s[28:31], s91 offen offset:192 nt
    v_lshlrev_b32 v72, 16, v4
    v_and_b32 v73, 0xffff0000, v4
    v_lshlrev_b32 v74, 16, v5
    v_and_b32 v75, 0xffff0000, v5
    v_max3_f32 v6, v68, v69, v70
    v_max3_f32 v6, v6, v71, v72
    v_max3_f32 v6, v6, v73, v74
    v_max3_f32 v6, v6, v75, v14
    v_mov_b32 v7, v6
    s_nop 1
    v_permlane32_swap_b32 v6, v7
    s_nop 0
    v_max_f32 v6, v6, v7
    v_mov_b32 v7, v6
    buffer_load_dwordx4 v[136:139], v12, s[28:31], s84 offen offset:0 nt
    s_nop 1
    v_permlane16_swap_b32 v6, v7
    s_nop 0
    v_max_f32 v6, v6, v7
    v_mul_f32 v7, s79, v6
    v_sub_f32 v8, v16, v7
    v_exp_f32 v8, v8
    v_mov_b32 v14, v6
    v_mov_b32 v16, v7
    v_fma_f32 v68, v68, s79, -v16
    v_fma_f32 v69, v69, s79, -v16
    v_fma_f32 v70, v70, s79, -v16
    v_fma_f32 v71, v71, s79, -v16
    v_fma_f32 v72, v72, s79, -v16
    buffer_load_dwordx4 v[140:143], v12, s[28:31], s84 offen offset:64 nt
    v_fma_f32 v73, v73, s79, -v16
    v_fma_f32 v74, v74, s79, -v16
    v_fma_f32 v75, v75, s79, -v16
    v_exp_f32 v68, v68
    v_exp_f32 v69, v69
    v_exp_f32 v70, v70
    v_exp_f32 v71, v71
    v_exp_f32 v72, v72
    v_exp_f32 v73, v73
    v_exp_f32 v74, v74
    v_exp_f32 v75, v75
    v_readlane_b32 s80, v8, 0
    v_readlane_b32 s81, v8, 1
    v_mul_f32 v15, v15, v8
    buffer_load_dwordx4 v[144:147], v12, s[28:31], s84 offen offset:128 nt
    v_cvt_pk_bf16_f32 v76, v68, v69
    v_cvt_pk_bf16_f32 v77, v70, v71
    v_cvt_pk_bf16_f32 v78, v72, v73
    v_cvt_pk_bf16_f32 v79, v74, v75
    v_add_f32 v15, v15, v68
    v_add_f32 v15, v15, v69
    v_add_f32 v15, v15, v70
    v_add_f32 v15, v15, v71
    v_add_f32 v15, v15, v72
    v_add_f32 v15, v15, v73
    v_add_f32 v15, v15, v74
    v_add_f32 v15, v15, v75
    v_mul_f32 v36, s80, v36
    v_mul_f32 v37, s81, v37
    buffer_load_dwordx4 v[148:151], v12, s[28:31], s84 offen offset:192 nt
    v_mul_f32 v40, s80, v40
    v_mul_f32 v41, s81, v41
    v_mul_f32 v44, s80, v44
    v_mul_f32 v45, s81, v45
    v_mul_f32 v48, s80, v48
    v_mul_f32 v49, s81, v49
    v_mul_f32 v52, s80, v52
    v_mul_f32 v53, s81, v53
    v_mul_f32 v56, s80, v56
    v_mul_f32 v57, s81, v57
    v_mul_f32 v60, s80, v60
    v_mul_f32 v61, s81, v61
    v_mul_f32 v64, s80, v64
    v_mul_f32 v65, s81, v65
    s_waitcnt vmcnt(24)
    v_perm_b32 v80, v156, v152, s76
    v_perm_b32 v81, v164, v160, s76
    v_perm_b32 v82, v172, v168, s76
    v_perm_b32 v83, v180, v176, s76
    v_perm_b32 v84, v156, v152, s77
    v_perm_b32 v85, v164, v160, s77
    v_perm_b32 v86, v172, v168, s77
    v_perm_b32 v87, v180, v176, s77
    v_mfma_f32_16x16x32_bf16 v[36:39], v[76:79], v[80:83], v[36:39]
    buffer_load_dwordx4 v[216:219], v13, s[32:35], s91 offen offset:0 nt
    v_perm_b32 v80, v157, v153, s76
    v_perm_b32 v81, v165, v161, s76
    v_perm_b32 v82, v173, v169, s76
    v_perm_b32 v83, v181, v177, s76
    v_mfma_f32_16x16x32_bf16 v[40:43], v[76:79], v[84:87], v[40:43]
    buffer_load_dwordx4 v[220:223], v13, s[32:35], s91 offen offset:1024 nt
    v_perm_b32 v84, v157, v153, s77
    v_perm_b32 v85, v165, v161, s77
    v_perm_b32 v86, v173, v169, s77
    v_perm_b32 v87, v181, v177, s77
    v_mfma_f32_16x16x32_bf16 v[44:47], v[76:79], v[80:83], v[44:47]
    buffer_load_dwordx4 v[224:227], v13, s[32:35], s91 offen offset:2048 nt
    v_perm_b32 v80, v158, v154, s76
    v_perm_b32 v81, v166, v162, s76
    v_perm_b32 v82, v174, v170, s76
    v_perm_b32 v83, v182, v178, s76
    v_mfma_f32_16x16x32_bf16 v[48:51], v[76:79], v[84:87], v[48:51]
    buffer_load_dwordx4 v[228:231], v13, s[32:35], s91 offen offset:3072 nt
    v_perm_b32 v84, v158, v154, s77
    v_perm_b32 v85, v166, v162, s77
    v_perm_b32 v86, v174, v170, s77
    v_perm_b32 v87, v182, v178, s77
    v_mfma_f32_16x16x32_bf16 v[52:55], v[76:79], v[80:83], v[52:55]
    buffer_load_dwordx4 v[232:235], v13, s[32:35], s84 offen offset:0 nt
    v_perm_b32 v80, v159, v155, s76
    v_perm_b32 v81, v167, v163, s76
    v_perm_b32 v82, v175, v171, s76
    v_perm_b32 v83, v183, v179, s76
    v_mfma_f32_16x16x32_bf16 v[56:59], v[76:79], v[84:87], v[56:59]
    buffer_load_dwordx4 v[236:239], v13, s[32:35], s84 offen offset:1024 nt
    v_perm_b32 v84, v159, v155, s77
    v_perm_b32 v85, v167, v163, s77
    v_perm_b32 v86, v175, v171, s77
    v_perm_b32 v87, v183, v179, s77
    v_mfma_f32_16x16x32_bf16 v[60:63], v[76:79], v[80:83], v[60:63]
    buffer_load_dwordx4 v[240:243], v13, s[32:35], s84 offen offset:2048 nt
    s_nop 1
    v_mfma_f32_16x16x32_bf16 v[64:67], v[76:79], v[84:87], v[64:67]
    buffer_load_dwordx4 v[244:247], v13, s[32:35], s84 offen offset:3072 nt
    s_cmp_ge_u32 s90, 1073741824
    s_cbranch_scc1 L_sdone
    s_waitcnt vmcnt(28)
    v_mfma_f32_16x16x32_bf16 v[68:71], v[88:91], v[20:23], 0
    v_mfma_f32_16x16x32_bf16 v[68:71], v[92:95], v[24:27], v[68:71]
    v_mfma_f32_16x16x32_bf16 v[68:71], v[96:99], v[28:31], v[68:71]
    v_mfma_f32_16x16x32_bf16 v[68:71], v[100:103], v[32:35], v[68:71]
    s_mov_b32 s89, s92
    s_cmp_gt_i32 s93, 0
    s_cbranch_scc1 L_ddn17
    s_mov_b32 s89, 1073741824
    s_cmp_lg_u32 s36, 0
    s_cbranch_scc1 L_ddn17
    v_mov_b32 v17, 1
    s_mov_b64 exec, 1
    ds_add_rtn_u32 v17, v253, v17 offset:44
    s_waitcnt lgkmcnt(0)
    v_readfirstlane_b32 s82, v17
    s_mov_b32 s85, 0x200000
L_dsp16:
    ds_read_b64 v[18:19], v253 offset:48
    s_waitcnt lgkmcnt(0)
    v_readfirstlane_b32 s81, v19
    v_readfirstlane_b32 s80, v18
    s_sub_u32 s85, s85, 1
    s_cmp_eq_u32 s85, 0
    s_cselect_b32 s81, 1, s81
    s_cmp_eq_u32 s81, 0
    s_cbranch_scc1 L_dsp16
    s_sub_u32 s81, s81, 1
    s_add_u32 s82, s82, s80
    s_cmp_ge_u32 s82, s81
    s_cbranch_scc1 L_dyn15
    s_lshr_b32 s80, s82, 3
    s_lshl_b32 s80, s80, 20
    s_and_b32 s81, s82, 7
    s_and_b32 s84, s81, 3
    s_lshr_b32 s81, s81, 2
    s_lshl_b32 s81, s81, 4
    s_add_u32 s81, s81, s84
    s_add_u32 s81, s81, 228
    s_lshl_b32 s81, s81, 12
    s_add_u32 s89, s80, s81
L_dyn15:
    s_mov_b64 exec, -1
    s_cmp_ge_u32 s89, 1073741824
    s_cselect_b32 s36, 1, 0
L_ddn17:
    s_cmp_eq_u32 s93, 15
    s_mov_b32 s82, 65536
    s_cselect_b32 s82, 4294000640, s82
    s_add_u32 s92, s92, s82
    s_sub_u32 s93, s93, 1
    s_add_u32 s84, s89, 32768
    s_waitcnt vmcnt(24)
    v_mfma_f32_16x16x32_bf16 v[72:75], v[104:107], v[20:23], 0
    v_mfma_f32_16x16x32_bf16 v[72:75], v[108:111], v[24:27], v[72:75]
    v_mfma_f32_16x16x32_bf16 v[72:75], v[112:115], v[28:31], v[72:75]
    v_mfma_f32_16x16x32_bf16 v[72:75], v[116:119], v[32:35], v[72:75]
    s_nop 3
    buffer_load_dwordx4 v[88:91], v12, s[28:31], s89 offen offset:0 nt
    buffer_load_dwordx4 v[92:95], v12, s[28:31], s89 offen offset:64 nt
    s_nop 2
    v_cvt_pk_bf16_f32 v2, v68, v69
    v_cvt_pk_bf16_f32 v3, v70, v71
    v_cvt_pk_bf16_f32 v4, v72, v73
    v_cvt_pk_bf16_f32 v5, v74, v75
    v_lshlrev_b32 v68, 16, v2
    v_and_b32 v69, 0xffff0000, v2
    v_lshlrev_b32 v70, 16, v3
    v_and_b32 v71, 0xffff0000, v3
    v_lshlrev_b32 v72, 16, v4
    v_and_b32 v73, 0xffff0000, v4
    v_lshlrev_b32 v74, 16, v5
    v_and_b32 v75, 0xffff0000, v5
    v_mul_f32 v68, s78, v68
    v_mul_f32 v69, s78, v69
    buffer_load_dwordx4 v[96:99], v12, s[28:31], s89 offen offset:128 nt
    v_mul_f32 v70, s78, v70
    v_mul_f32 v71, s78, v71
    v_mul_f32 v72, s78, v72
    v_mul_f32 v73, s78, v73
    v_mul_f32 v74, s78, v74
    v_mul_f32 v75, s78, v75
    v_cvt_pk_bf16_f32 v2, v68, v69
    v_cvt_pk_bf16_f32 v3, v70, v71
    v_cvt_pk_bf16_f32 v4, v72, v73
    v_cvt_pk_bf16_f32 v5, v74, v75
    v_lshlrev_b32 v68, 16, v2
    v_and_b32 v69, 0xffff0000, v2
    v_lshlrev_b32 v70, 16, v3
    v_and_b32 v71, 0xffff0000, v3
    buffer_load_dwordx4 v[100:103], v12, s[28:31], s89 offen offset:192 nt
    v_lshlrev_b32 v72, 16, v4
    v_and_b32 v73, 0xffff0000, v4
    v_lshlrev_b32 v74, 16, v5
    v_and_b32 v75, 0xffff0000, v5
    v_max3_f32 v6, v68, v69, v70
    v_max3_f32 v6, v6, v71, v72
    v_max3_f32 v6, v6, v73, v74
    v_max3_f32 v6, v6, v75, v14
    v_mov_b32 v7, v6
    s_nop 1
    v_permlane32_swap_b32 v6, v7
    s_nop 0
    v_max_f32 v6, v6, v7
    v_mov_b32 v7, v6
    buffer_load_dwordx4 v[104:107], v12, s[28:31], s84 offen offset:0 nt
    s_nop 1
    v_permlane16_swap_b32 v6, v7
    s_nop 0
    v_max_f32 v6, v6, v7
    v_mul_f32 v7, s79, v6
    v_sub_f32 v8, v16, v7
    v_exp_f32 v8, v8
    v_mov_b32 v14, v6
    v_mov_b32 v16, v7
    v_fma_f32 v68, v68, s79, -v16
    v_fma_f32 v69, v69, s79, -v16
    v_fma_f32 v70, v70, s79, -v16
    v_fma_f32 v71, v71, s79, -v16
    v_fma_f32 v72, v72, s79, -v16
    buffer_load_dwordx4 v[108:111], v12, s[28:31], s84 offen offset:64 nt
    v_fma_f32 v73, v73, s79, -v16
    v_fma_f32 v74, v74, s79, -v16
    v_fma_f32 v75, v75, s79, -v16
    v_exp_f32 v68, v68
    v_exp_f32 v69, v69
    v_exp_f32 v70, v70
    v_exp_f32 v71, v71
    v_exp_f32 v72, v72
    v_exp_f32 v73, v73
    v_exp_f32 v74, v74
    v_exp_f32 v75, v75
    v_readlane_b32 s80, v8, 0
    v_readlane_b32 s81, v8, 1
    v_mul_f32 v15, v15, v8
    buffer_load_dwordx4 v[112:115], v12, s[28:31], s84 offen offset:128 nt
    v_cvt_pk_bf16_f32 v76, v68, v69
    v_cvt_pk_bf16_f32 v77, v70, v71
    v_cvt_pk_bf16_f32 v78, v72, v73
    v_cvt_pk_bf16_f32 v79, v74, v75
    v_add_f32 v15, v15, v68
    v_add_f32 v15, v15, v69
    v_add_f32 v15, v15, v70
    v_add_f32 v15, v15, v71
    v_add_f32 v15, v15, v72
    v_add_f32 v15, v15, v73
    v_add_f32 v15, v15, v74
    v_add_f32 v15, v15, v75
    v_mul_f32 v36, s80, v36
    v_mul_f32 v37, s81, v37
    buffer_load_dwordx4 v[116:119], v12, s[28:31], s84 offen offset:192 nt
    v_mul_f32 v40, s80, v40
    v_mul_f32 v41, s81, v41
    v_mul_f32 v44, s80, v44
    v_mul_f32 v45, s81, v45
    v_mul_f32 v48, s80, v48
    v_mul_f32 v49, s81, v49
    v_mul_f32 v52, s80, v52
    v_mul_f32 v53, s81, v53
    v_mul_f32 v56, s80, v56
    v_mul_f32 v57, s81, v57
    v_mul_f32 v60, s80, v60
    v_mul_f32 v61, s81, v61
    v_mul_f32 v64, s80, v64
    v_mul_f32 v65, s81, v65
    s_waitcnt vmcnt(24)
    v_perm_b32 v80, v188, v184, s76
    v_perm_b32 v81, v196, v192, s76
    v_perm_b32 v82, v204, v200, s76
    v_perm_b32 v83, v212, v208, s76
    v_perm_b32 v84, v188, v184, s77
    v_perm_b32 v85, v196, v192, s77
    v_perm_b32 v86, v204, v200, s77
    v_perm_b32 v87, v212, v208, s77
    v_mfma_f32_16x16x32_bf16 v[36:39], v[76:79], v[80:83], v[36:39]
    buffer_load_dwordx4 v[152:155], v13, s[32:35], s89 offen offset:0 nt
    v_perm_b32 v80, v189, v185, s76
    v_perm_b32 v81, v197, v193, s76
    v_perm_b32 v82, v205, v201, s76
    v_perm_b32 v83, v213, v209, s76
    v_mfma_f32_16x16x32_bf16 v[40:43], v[76:79], v[84:87], v[40:43]
    buffer_load_dwordx4 v[156:159], v13, s[32:35], s89 offen offset:1024 nt
    v_perm_b32 v84, v189, v185, s77
    v_perm_b32 v85, v197, v193, s77
    v_perm_b32 v86, v205, v201, s77
    v_perm_b32 v87, v213, v209, s77
    v_mfma_f32_16x16x32_bf16 v[44:47], v[76:79], v[80:83], v[44:47]
    buffer_load_dwordx4 v[160:163], v13, s[32:35], s89 offen offset:2048 nt
    v_perm_b32 v80, v190, v186, s76
    v_perm_b32 v81, v198, v194, s76
    v_perm_b32 v82, v206, v202, s76
    v_perm_b32 v83, v214, v210, s76
    v_mfma_f32_16x16x32_bf16 v[48:51], v[76:79], v[84:87], v[48:51]
    buffer_load_dwordx4 v[164:167], v13, s[32:35], s89 offen offset:3072 nt
    v_perm_b32 v84, v190, v186, s77
    v_perm_b32 v85, v198, v194, s77
    v_perm_b32 v86, v206, v202, s77
    v_perm_b32 v87, v214, v210, s77
    v_mfma_f32_16x16x32_bf16 v[52:55], v[76:79], v[80:83], v[52:55]
    buffer_load_dwordx4 v[168:171], v13, s[32:35], s84 offen offset:0 nt
    v_perm_b32 v80, v191, v187, s76
    v_perm_b32 v81, v199, v195, s76
    v_perm_b32 v82, v207, v203, s76
    v_perm_b32 v83, v215, v211, s76
    v_mfma_f32_16x16x32_bf16 v[56:59], v[76:79], v[84:87], v[56:59]
    buffer_load_dwordx4 v[172:175], v13, s[32:35], s84 offen offset:1024 nt
    v_perm_b32 v84, v191, v187, s77
    v_perm_b32 v85, v199, v195, s77
    v_perm_b32 v86, v207, v203, s77
    v_perm_b32 v87, v215, v211, s77
    v_mfma_f32_16x16x32_bf16 v[60:63], v[76:79], v[80:83], v[60:63]
    buffer_load_dwordx4 v[176:179], v13, s[32:35], s84 offen offset:2048 nt
    s_nop 1
    v_mfma_f32_16x16x32_bf16 v[64:67], v[76:79], v[84:87], v[64:67]
    buffer_load_dwordx4 v[180:183], v13, s[32:35], s84 offen offset:3072 nt
    s_cmp_ge_u32 s91, 1073741824
    s_cbranch_scc1 L_sdone
    s_waitcnt vmcnt(28)
    v_mfma_f32_16x16x32_bf16 v[68:71], v[120:123], v[20:23], 0
    v_mfma_f32_16x16x32_bf16 v[68:71], v[124:127], v[24:27], v[68:71]
    v_mfma_f32_16x16x32_bf16 v[68:71], v[128:131], v[28:31], v[68:71]
    v_mfma_f32_16x16x32_bf16 v[68:71], v[132:135], v[32:35], v[68:71]
    s_mov_b32 s90, s92
    s_cmp_gt_i32 s93, 0
    s_cbranch_scc1 L_ddn20
    s_mov_b32 s90, 1073741824
    s_cmp_lg_u32 s36, 0
    s_cbranch_scc1 L_ddn20
    v_mov_b32 v17, 1
    s_mov_b64 exec, 1
    ds_add_rtn_u32 v17, v253, v17 offset:44
    s_waitcnt lgkmcnt(0)
    v_readfirstlane_b32 s82, v17
    s_mov_b32 s85, 0x200000
L_dsp19:
    ds_read_b64 v[18:19], v253 offset:48
    s_waitcnt lgkmcnt(0)
    v_readfirstlane_b32 s81, v19
    v_readfirstlane_b32 s80, v18
    s_sub_u32 s85, s85, 1
    s_cmp_eq_u32 s85, 0
    s_cselect_b32 s81, 1, s81
    s_cmp_eq_u32 s81, 0
    s_cbranch_scc1 L_dsp19
    s_sub_u32 s81, s81, 1
    s_add_u32 s82, s82, s80
    s_cmp_ge_u32 s82, s81
    s_cbranch_scc1 L_dyn18
    s_lshr_b32 s80, s82, 3
    s_lshl_b32 s80, s80, 20
    s_and_b32 s81, s82, 7
    s_and_b32 s84, s81, 3
    s_lshr_b32 s81, s81, 2
    s_lshl_b32 s81, s81, 4
    s_add_u32 s81, s81, s84
    s_add_u32 s81, s81, 228
    s_lshl_b32 s81, s81, 12
    s_add_u32 s90, s80, s81
L_dyn18:
    s_mov_b64 exec, -1
    s_cmp_ge_u32 s90, 1073741824
    s_cselect_b32 s36, 1, 0
L_ddn20:
    s_cmp_eq_u32 s93, 15
    s_mov_b32 s82, 65536
    s_cselect_b32 s82, 4294000640, s82
    s_add_u32 s92, s92, s82
    s_sub_u32 s93, s93, 1
    s_add_u32 s84, s90, 32768
    s_waitcnt vmcnt(24)
    v_mfma_f32_16x16x32_bf16 v[72:75], v[136:139], v[20:23], 0
    v_mfma_f32_16x16x32_bf16 v[72:75], v[140:143], v[24:27], v[72:75]
    v_mfma_f32_16x16x32_bf16 v[72:75], v[144:147], v[28:31], v[72:75]
    v_mfma_f32_16x16x32_bf16 v[72:75], v[148:151], v[32:35], v[72:75]
    s_nop 3
    buffer_load_dwordx4 v[120:123], v12, s[28:31], s90 offen offset:0 nt
    buffer_load_dwordx4 v[124:127], v12, s[28:31], s90 offen offset:64 nt
    s_nop 2
    v_cvt_pk_bf16_f32 v2, v68, v69
    v_cvt_pk_bf16_f32 v3, v70, v71
    v_cvt_pk_bf16_f32 v4, v72, v73
    v_cvt_pk_bf16_f32 v5, v74, v75
    v_lshlrev_b32 v68, 16, v2
    v_and_b32 v69, 0xffff0000, v2
    v_lshlrev_b32 v70, 16, v3
    v_and_b32 v71, 0xffff0000, v3
    v_lshlrev_b32 v72, 16, v4
    v_and_b32 v73, 0xffff0000, v4
    v_lshlrev_b32 v74, 16, v5
    v_and_b32 v75, 0xffff0000, v5
    v_mul_f32 v68, s78, v68
    v_mul_f32 v69, s78, v69
    buffer_load_dwordx4 v[128:131], v12, s[28:31], s90 offen offset:128 nt
    v_mul_f32 v70, s78, v70
    v_mul_f32 v71, s78, v71
    v_mul_f32 v72, s78, v72
    v_mul_f32 v73, s78, v73
    v_mul_f32 v74, s78, v74
    v_mul_f32 v75, s78, v75
    v_cvt_pk_bf16_f32 v2, v68, v69
    v_cvt_pk_bf16_f32 v3, v70, v71
    v_cvt_pk_bf16_f32 v4, v72, v73
    v_cvt_pk_bf16_f32 v5, v74, v75
    v_lshlrev_b32 v68, 16, v2
    v_and_b32 v69, 0xffff0000, v2
    v_lshlrev_b32 v70, 16, v3
    v_and_b32 v71, 0xffff0000, v3
    buffer_load_dwordx4 v[132:135], v12, s[28:31], s90 offen offset:192 nt
    v_lshlrev_b32 v72, 16, v4
    v_and_b32 v73, 0xffff0000, v4
    v_lshlrev_b32 v74, 16, v5
    v_and_b32 v75, 0xffff0000, v5
    v_max3_f32 v6, v68, v69, v70
    v_max3_f32 v6, v6, v71, v72
    v_max3_f32 v6, v6, v73, v74
    v_max3_f32 v6, v6, v75, v14
    v_mov_b32 v7, v6
    s_nop 1
    v_permlane32_swap_b32 v6, v7
    s_nop 0
    v_max_f32 v6, v6, v7
    v_mov_b32 v7, v6
    buffer_load_dwordx4 v[136:139], v12, s[28:31], s84 offen offset:0 nt
    s_nop 1
    v_permlane16_swap_b32 v6, v7
    s_nop 0
    v_max_f32 v6, v6, v7
    v_mul_f32 v7, s79, v6
    v_sub_f32 v8, v16, v7
    v_exp_f32 v8, v8
    v_mov_b32 v14, v6
    v_mov_b32 v16, v7
    v_fma_f32 v68, v68, s79, -v16
    v_fma_f32 v69, v69, s79, -v16
    v_fma_f32 v70, v70, s79, -v16
    v_fma_f32 v71, v71, s79, -v16
    v_fma_f32 v72, v72, s79, -v16
    buffer_load_dwordx4 v[140:143], v12, s[28:31], s84 offen offset:64 nt
    v_fma_f32 v73, v73, s79, -v16
    v_fma_f32 v74, v74, s79, -v16
    v_fma_f32 v75, v75, s79, -v16
    v_exp_f32 v68, v68
    v_exp_f32 v69, v69
    v_exp_f32 v70, v70
    v_exp_f32 v71, v71
    v_exp_f32 v72, v72
    v_exp_f32 v73, v73
    v_exp_f32 v74, v74
    v_exp_f32 v75, v75
    v_readlane_b32 s80, v8, 0
    v_readlane_b32 s81, v8, 1
    v_mul_f32 v15, v15, v8
    buffer_load_dwordx4 v[144:147], v12, s[28:31], s84 offen offset:128 nt
    v_cvt_pk_bf16_f32 v76, v68, v69
    v_cvt_pk_bf16_f32 v77, v70, v71
    v_cvt_pk_bf16_f32 v78, v72, v73
    v_cvt_pk_bf16_f32 v79, v74, v75
    v_add_f32 v15, v15, v68
    v_add_f32 v15, v15, v69
    v_add_f32 v15, v15, v70
    v_add_f32 v15, v15, v71
    v_add_f32 v15, v15, v72
    v_add_f32 v15, v15, v73
    v_add_f32 v15, v15, v74
    v_add_f32 v15, v15, v75
    v_mul_f32 v36, s80, v36
    v_mul_f32 v37, s81, v37
    buffer_load_dwordx4 v[148:151], v12, s[28:31], s84 offen offset:192 nt
    v_mul_f32 v40, s80, v40
    v_mul_f32 v41, s81, v41
    v_mul_f32 v44, s80, v44
    v_mul_f32 v45, s81, v45
    v_mul_f32 v48, s80, v48
    v_mul_f32 v49, s81, v49
    v_mul_f32 v52, s80, v52
    v_mul_f32 v53, s81, v53
    v_mul_f32 v56, s80, v56
    v_mul_f32 v57, s81, v57
    v_mul_f32 v60, s80, v60
    v_mul_f32 v61, s81, v61
    v_mul_f32 v64, s80, v64
    v_mul_f32 v65, s81, v65
    s_waitcnt vmcnt(24)
    v_perm_b32 v80, v220, v216, s76
    v_perm_b32 v81, v228, v224, s76
    v_perm_b32 v82, v236, v232, s76
    v_perm_b32 v83, v244, v240, s76
    v_perm_b32 v84, v220, v216, s77
    v_perm_b32 v85, v228, v224, s77
    v_perm_b32 v86, v236, v232, s77
    v_perm_b32 v87, v244, v240, s77
    v_mfma_f32_16x16x32_bf16 v[36:39], v[76:79], v[80:83], v[36:39]
    buffer_load_dwordx4 v[184:187], v13, s[32:35], s90 offen offset:0 nt
    v_perm_b32 v80, v221, v217, s76
    v_perm_b32 v81, v229, v225, s76
    v_perm_b32 v82, v237, v233, s76
    v_perm_b32 v83, v245, v241, s76
    v_mfma_f32_16x16x32_bf16 v[40:43], v[76:79], v[84:87], v[40:43]
    buffer_load_dwordx4 v[188:191], v13, s[32:35], s90 offen offset:1024 nt
    v_perm_b32 v84, v221, v217, s77
    v_perm_b32 v85, v229, v225, s77
    v_perm_b32 v86, v237, v233, s77
    v_perm_b32 v87, v245, v241, s77
    v_mfma_f32_16x16x32_bf16 v[44:47], v[76:79], v[80:83], v[44:47]
    buffer_load_dwordx4 v[192:195], v13, s[32:35], s90 offen offset:2048 nt
    v_perm_b32 v80, v222, v218, s76
    v_perm_b32 v81, v230, v226, s76
    v_perm_b32 v82, v238, v234, s76
    v_perm_b32 v83, v246, v242, s76
    v_mfma_f32_16x16x32_bf16 v[48:51], v[76:79], v[84:87], v[48:51]
    buffer_load_dwordx4 v[196:199], v13, s[32:35], s90 offen offset:3072 nt
    v_perm_b32 v84, v222, v218, s77
    v_perm_b32 v85, v230, v226, s77
    v_perm_b32 v86, v238, v234, s77
    v_perm_b32 v87, v246, v242, s77
    v_mfma_f32_16x16x32_bf16 v[52:55], v[76:79], v[80:83], v[52:55]
    buffer_load_dwordx4 v[200:203], v13, s[32:35], s84 offen offset:0 nt
    v_perm_b32 v80, v223, v219, s76
    v_perm_b32 v81, v231, v227, s76
    v_perm_b32 v82, v239, v235, s76
    v_perm_b32 v83, v247, v243, s76
    v_mfma_f32_16x16x32_bf16 v[56:59], v[76:79], v[84:87], v[56:59]
    buffer_load_dwordx4 v[204:207], v13, s[32:35], s84 offen offset:1024 nt
    v_perm_b32 v84, v223, v219, s77
    v_perm_b32 v85, v231, v227, s77
    v_perm_b32 v86, v239, v235, s77
    v_perm_b32 v87, v247, v243, s77
    v_mfma_f32_16x16x32_bf16 v[60:63], v[76:79], v[80:83], v[60:63]
    buffer_load_dwordx4 v[208:211], v13, s[32:35], s84 offen offset:2048 nt
    s_nop 1
    v_mfma_f32_16x16x32_bf16 v[64:67], v[76:79], v[84:87], v[64:67]
    buffer_load_dwordx4 v[212:215], v13, s[32:35], s84 offen offset:3072 nt
    v_mov_b32 v11, 1
    s_mov_b64 exec, 1
    ds_add_rtn_u32 v11, v253, v11 offset:40
    s_memrealtime s[94:95]
    s_waitcnt lgkmcnt(0)
    v_readfirstlane_b32 s82, v11
    s_cmp_lg_u32 s82, 14
    s_cbranch_scc1 L_nt21
    s_or_b32 s82, s94, 1
    v_mov_b32 v11, s82
    ds_write_b32 v253, v11 offset:56
L_nt21:
    s_mov_b64 exec, -1
    s_branch L_loop
L_sdone:
    v_mov_b32 v2, v15
    s_nop 1
    v_permlane32_swap_b32 v15, v2
    s_nop 0
    v_add_f32 v15, v15, v2
    v_mov_b32 v2, v15
    s_nop 1
    v_permlane16_swap_b32 v15, v2
    s_nop 0
    v_add_f32 v15, v15, v2
    s_nop 7
    s_mul_i32 s82, s74, 1056
    v_lshlrev_b32 v2, 5, v1
    v_add_u32 v2, s82, v2
    v_add_u32 v2, 20544, v2
    v_lshlrev_b32 v3, 2, v1
    v_add_u32 v3, s82, v3
    s_mov_b64 exec, 0xffff
    ds_write2_b32 v2, v36, v40 offset0:0 offset1:1
    ds_write2_b32 v2, v44, v48 offset0:2 offset1:3
    ds_write2_b32 v2, v52, v56 offset0:4 offset1:5
    ds_write2_b32 v2, v60, v64 offset0:6 offset1:7
    ds_write2_b32 v2, v37, v41 offset0:128 offset1:129
    ds_write2_b32 v2, v45, v49 offset0:130 offset1:131
    ds_write2_b32 v2, v53, v57 offset0:132 offset1:133
    ds_write2_b32 v2, v61, v65 offset0:134 offset1:135
    s_mov_b64 exec, 3
    ds_write_b32 v3, v16 offset:21568
    ds_write_b32 v3, v15 offset:21576
    s_mov_b64 exec, -1
    s_waitcnt lgkmcnt(0)
    v_mov_b32 v4, 1
    s_mov_b64 exec, 1
    ds_add_u32 v253, v4 offset:20
    s_mov_b64 exec, -1
    s_branch L_end
L_helper:
    s_setprio 3
    s_sub_u32 s89, s74, 4
    s_cmp_lg_u32 s74, 7
    s_cbranch_scc1 L_nz
    v_lshlrev_b32 v2, 2, v1
    s_mov_b64 exec, 0xffff
    ds_write_b32 v2, v253 offset:0
    s_mov_b64 exec, -1
    v_lshlrev_b32 v2, 4, v1
    v_mov_b32 v16, -1
    v_mov_b32 v17, -1
    v_mov_b32 v18, -1
    v_mov_b32 v19, -1
    ds_write_b128 v2, v[16:19] offset:46784
    ds_write_b128 v2, v[16:19] offset:47808
    ds_write_b128 v2, v[16:19] offset:48832
    ds_write_b128 v2, v[16:19] offset:49856
    s_waitcnt lgkmcnt(0)
L_nz:
    s_mov_b32 s36, s4
    s_and_b32 s37, s5, 0xffff
    s_mov_b32 s38, 1152
    s_mov_b32 s39, 0x20000
    s_mov_b32 s40, s10
    s_and_b32 s41, s11, 0xffff
    s_mov_b32 s42, 4718592
    s_mov_b32 s43, 0x20000
    s_mov_b32 s68, s24
    s_and_b32 s69, s25, 0xffff
    s_mov_b32 s70, 256
    s_mov_b32 s71, 0x20000
    s_cmp_eq_u32 s74, 7
    s_cbranch_scc1 L_w7start
    v_lshlrev_b32 v5, 2, v1
    buffer_load_dword v16, v5, s[36:39], 0 offen offset:0
    buffer_load_dword v17, v5, s[36:39], 0 offen offset:256
    buffer_load_dword v18, v5, s[36:39], 0 offen offset:512
    buffer_load_dword v19, v5, s[36:39], 0 offen offset:768
    buffer_load_dword v20, v5, s[36:39], 0 offen offset:1024
    v_lshrrev_b32 v2, 3, v1
    s_mul_i32 s82, s100, 144
    s_mul_i32 s83, s89, 48
    s_add_u32 s82, s82, s83
    v_add_u32 v3, s82, v2
    v_lshlrev_b32 v7, 2, v3
    v_lshlrev_b32 v6, 13, v3
    v_and_b32 v3, 7, v1
    v_lshl_add_u32 v6, v3, 4, v6
    s_lshl_b32 s82, s72, 9
    s_lshl_b32 s83, s101, 7
    s_add_u32 s82, s82, s83
    v_add_u32 v6, s82, v6
    s_mov_b32 s84, 0
    buffer_load_dwordx4 v[76:79], v6, s[40:43], s84 offen nt
    s_mov_b32 s84, 65536
    buffer_load_dwordx4 v[80:83], v6, s[40:43], s84 offen nt
    s_mov_b32 s84, 131072
    buffer_load_dwordx4 v[84:87], v6, s[40:43], s84 offen nt
    s_mov_b32 s84, 196608
    buffer_load_dwordx4 v[88:91], v6, s[40:43], s84 offen nt
    s_mov_b32 s84, 262144
    buffer_load_dwordx4 v[92:95], v6, s[40:43], s84 offen nt
    s_mov_b32 s84, 327680
    buffer_load_dwordx4 v[96:99], v6, s[40:43], s84 offen nt
    s_branch L_nononce
L_w7start:
    s_mov_b32 s90, s88
    s_mov_b32 s91, 0
    s_atomic_cmpswap s[90:91], s[24:25], 0x0 glc
    s_mov_b64 exec, 1
    s_lshl_b32 s82, s72, 7
    s_lshl_b32 s83, s73, 2
    s_add_u32 s82, s82, s83
    s_add_u32 s82, s82, 2494464
    buffer_store_dword v253, v253, s[60:63], s82 offen sc1
    s_mov_b64 exec, -1
L_nononce:
    s_barrier
    s_mov_b32 s44, s16
    s_and_b32 s45, s17, 0xffff
    s_mov_b32 s46, 5308416
    s_mov_b32 s47, 0x20000
    s_mov_b32 s48, s18
    s_and_b32 s49, s19, 0xffff
    s_mov_b32 s50, 5308416
    s_mov_b32 s51, 0x20000
    s_mov_b32 s52, s12
    s_and_b32 s53, s13, 0xffff
    s_mov_b32 s54, 4718592
    s_mov_b32 s55, 0x20000
    s_mov_b32 s56, s20
    s_and_b32 s57, s21, 0xffff
    s_mov_b32 s58, 5308416
    s_mov_b32 s59, 0x20000
    s_mov_b32 s64, s22
    s_and_b32 s65, s23, 0xffff
    s_mov_b32 s66, 1152
    s_mov_b32 s67, 0x20000
    s_cmp_eq_u32 s74, 7
    s_cbranch_scc1 L_w7x
    s_waitcnt vmcnt(6)
    v_lshlrev_b32 v48, 16, v16
    v_and_b32 v49, 0xffff0000, v16
    v_lshlrev_b32 v50, 16, v17
    v_and_b32 v51, 0xffff0000, v17
    v_lshlrev_b32 v52, 16, v18
    v_and_b32 v53, 0xffff0000, v18
    v_lshlrev_b32 v54, 16, v19
    v_and_b32 v55, 0xffff0000, v19
    v_lshlrev_b32 v56, 16, v20
    v_and_b32 v57, 0xffff0000, v20
    v_add_f32 v2, v48, v49
    v_add_f32 v2, v2, v50
    v_add_f32 v2, v2, v51
    v_add_f32 v2, v2, v52
    v_add_f32 v2, v2, v53
    v_add_f32 v2, v2, v54
    v_add_f32 v2, v2, v55
    v_add_f32 v2, v2, v56
    v_add_f32 v2, v2, v57
    s_nop 1
    v_add_f32_dpp v2, v2, v2 quad_perm:[1,0,3,2] row_mask:0xf bank_mask:0xf
    s_nop 1
    v_add_f32_dpp v2, v2, v2 quad_perm:[2,3,0,1] row_mask:0xf bank_mask:0xf
    s_nop 1
    v_add_f32_dpp v2, v2, v2 row_half_mirror row_mask:0xf bank_mask:0xf
    s_nop 1
    v_add_f32_dpp v2, v2, v2 row_mirror row_mask:0xf bank_mask:0xf
    v_mov_b32 v3, v2
    s_nop 1
    v_permlane32_swap_b32 v2, v3
    s_nop 0
    v_add_f32 v2, v2, v3
    v_mov_b32 v3, v2
    s_nop 1
    v_permlane16_swap_b32 v2, v3
    s_nop 0
    v_add_f32 v2, v2, v3
    v_mul_f32 v2, 0x3ae38e39, v2
    v_cmp_gt_u32 vcc, 32, v1
    v_mov_b32 v4, 0
    v_sub_f32 v3, v48, v2
    v_fmac_f32 v4, v3, v3
    v_sub_f32 v3, v49, v2
    v_fmac_f32 v4, v3, v3
    v_sub_f32 v3, v50, v2
    v_fmac_f32 v4, v3, v3
    v_sub_f32 v3, v51, v2
    v_fmac_f32 v4, v3, v3
    v_sub_f32 v3, v52, v2
    v_fmac_f32 v4, v3, v3
    v_sub_f32 v3, v53, v2
    v_fmac_f32 v4, v3, v3
    v_sub_f32 v3, v54, v2
    v_fmac_f32 v4, v3, v3
    v_sub_f32 v3, v55, v2
    v_fmac_f32 v4, v3, v3
    v_sub_f32 v3, v56, v2
    v_cndmask_b32 v3, 0, v3, vcc
    v_fmac_f32 v4, v3, v3
    v_sub_f32 v3, v57, v2
    v_cndmask_b32 v3, 0, v3, vcc
    v_fmac_f32 v4, v3, v3
    s_nop 1
    v_add_f32_dpp v4, v4, v4 quad_perm:[1,0,3,2] row_mask:0xf bank_mask:0xf
    s_nop 1
    v_add_f32_dpp v4, v4, v4 quad_perm:[2,3,0,1] row_mask:0xf bank_mask:0xf
    s_nop 1
    v_add_f32_dpp v4, v4, v4 row_half_mirror row_mask:0xf bank_mask:0xf
    s_nop 1
    v_add_f32_dpp v4, v4, v4 row_mirror row_mask:0xf bank_mask:0xf
    v_mov_b32 v3, v4
    s_nop 1
    v_permlane32_swap_b32 v4, v3
    s_nop 0
    v_add_f32 v4, v4, v3
    v_mov_b32 v3, v4
    s_nop 1
    v_permlane16_swap_b32 v4, v3
    s_nop 0
    v_add_f32 v4, v4, v3
    v_mul_f32 v4, 0x3ae38e39, v4
    v_cvt_pk_bf16_f32 v2, v2, v2
    v_lshlrev_b32 v2, 16, v2
    v_cvt_pk_bf16_f32 v4, v4, v4
    v_lshlrev_b32 v4, 16, v4
    v_add_f32 v4, 0x3727c5ac, v4
    v_cvt_pk_bf16_f32 v4, v4, v4
    v_lshlrev_b32 v4, 16, v4
    v_sqrt_f32 v4, v4
    s_nop 0
    v_cvt_pk_bf16_f32 v4, v4, v4
    v_lshlrev_b32 v4, 16, v4
    v_rcp_f32 v3, v4
    s_nop 0
    v_sub_f32 v48, v48, v2
    v_cvt_pk_bf16_f32 v48, v48, v48
    v_lshlrev_b32 v48, 16, v48
    v_mul_f32 v8, v48, v3
    v_fma_f32 v9, -v8, v4, v48
    v_fma_f32 v48, v9, v3, v8
    v_cvt_pk_bf16_f32 v48, v48, v48
    v_lshlrev_b32 v48, 16, v48
    v_sub_f32 v49, v49, v2
    v_cvt_pk_bf16_f32 v49, v49, v49
    v_lshlrev_b32 v49, 16, v49
    v_mul_f32 v8, v49, v3
    v_fma_f32 v9, -v8, v4, v49
    v_fma_f32 v49, v9, v3, v8
    v_cvt_pk_bf16_f32 v49, v49, v49
    v_lshlrev_b32 v49, 16, v49
    v_sub_f32 v50, v50, v2
    v_cvt_pk_bf16_f32 v50, v50, v50
    v_lshlrev_b32 v50, 16, v50
    v_mul_f32 v8, v50, v3
    v_fma_f32 v9, -v8, v4, v50
    v_fma_f32 v50, v9, v3, v8
    v_cvt_pk_bf16_f32 v50, v50, v50
    v_lshlrev_b32 v50, 16, v50
    v_sub_f32 v51, v51, v2
    v_cvt_pk_bf16_f32 v51, v51, v51
    v_lshlrev_b32 v51, 16, v51
    v_mul_f32 v8, v51, v3
    v_fma_f32 v9, -v8, v4, v51
    v_fma_f32 v51, v9, v3, v8
    v_cvt_pk_bf16_f32 v51, v51, v51
    v_lshlrev_b32 v51, 16, v51
    v_sub_f32 v52, v52, v2
    v_cvt_pk_bf16_f32 v52, v52, v52
    v_lshlrev_b32 v52, 16, v52
    v_mul_f32 v8, v52, v3
    v_fma_f32 v9, -v8, v4, v52
    v_fma_f32 v52, v9, v3, v8
    v_cvt_pk_bf16_f32 v52, v52, v52
    v_lshlrev_b32 v52, 16, v52
    v_sub_f32 v53, v53, v2
    v_cvt_pk_bf16_f32 v53, v53, v53
    v_lshlrev_b32 v53, 16, v53
    v_mul_f32 v8, v53, v3
    v_fma_f32 v9, -v8, v4, v53
    v_fma_f32 v53, v9, v3, v8
    v_cvt_pk_bf16_f32 v53, v53, v53
    v_lshlrev_b32 v53, 16, v53
    v_sub_f32 v54, v54, v2
    v_cvt_pk_bf16_f32 v54, v54, v54
    v_lshlrev_b32 v54, 16, v54
    v_mul_f32 v8, v54, v3
    v_fma_f32 v9, -v8, v4, v54
    v_fma_f32 v54, v9, v3, v8
    v_cvt_pk_bf16_f32 v54, v54, v54
    v_lshlrev_b32 v54, 16, v54
    v_sub_f32 v55, v55, v2
    v_cvt_pk_bf16_f32 v55, v55, v55
    v_lshlrev_b32 v55, 16, v55
    v_mul_f32 v8, v55, v3
    v_fma_f32 v9, -v8, v4, v55
    v_fma_f32 v55, v9, v3, v8
    v_cvt_pk_bf16_f32 v55, v55, v55
    v_lshlrev_b32 v55, 16, v55
    v_sub_f32 v56, v56, v2
    v_cvt_pk_bf16_f32 v56, v56, v56
    v_lshlrev_b32 v56, 16, v56
    v_mul_f32 v8, v56, v3
    v_fma_f32 v9, -v8, v4, v56
    v_fma_f32 v56, v9, v3, v8
    v_cvt_pk_bf16_f32 v56, v56, v56
    v_lshlrev_b32 v56, 16, v56
    v_cndmask_b32 v56, 0, v56, vcc
    v_sub_f32 v57, v57, v2
    v_cvt_pk_bf16_f32 v57, v57, v57
    v_lshlrev_b32 v57, 16, v57
    v_mul_f32 v8, v57, v3
    v_fma_f32 v9, -v8, v4, v57
    v_fma_f32 v57, v9, v3, v8
    v_cvt_pk_bf16_f32 v57, v57, v57
    v_lshlrev_b32 v57, 16, v57
    v_cndmask_b32 v57, 0, v57, vcc
    v_lshlrev_b32 v2, 3, v1
    ds_write_b64 v2, v[48:49] offset:64
    ds_write_b64 v2, v[50:51] offset:576
    ds_write_b64 v2, v[52:53] offset:1088
    ds_write_b64 v2, v[54:55] offset:1600
    ds_write_b64 v2, v[56:57] offset:2112
    ds_read_b32 v16, v7 offset:64
    ds_read_b32 v17, v7 offset:96
    ds_read_b32 v18, v7 offset:128
    ds_read_b32 v19, v7 offset:160
    ds_read_b32 v20, v7 offset:192
    ds_read_b32 v21, v7 offset:224
    s_waitcnt vmcnt(0) lgkmcnt(0)
    v_lshlrev_b32 v2, 16, v76
    v_and_b32 v3, 0xffff0000, v76
    v_mul_f32 v60, v2, v16
    v_mul_f32 v61, v3, v16
    v_lshlrev_b32 v2, 16, v77
    v_and_b32 v3, 0xffff0000, v77
    v_mul_f32 v62, v2, v16
    v_mul_f32 v63, v3, v16
    v_lshlrev_b32 v2, 16, v78
    v_and_b32 v3, 0xffff0000, v78
    v_mul_f32 v64, v2, v16
    v_mul_f32 v65, v3, v16
    v_lshlrev_b32 v2, 16, v79
    v_and_b32 v3, 0xffff0000, v79
    v_mul_f32 v66, v2, v16
    v_mul_f32 v67, v3, v16
    v_lshlrev_b32 v2, 16, v80
    v_and_b32 v3, 0xffff0000, v80
    v_fmac_f32 v60, v2, v17
    v_fmac_f32 v61, v3, v17
    v_lshlrev_b32 v2, 16, v81
    v_and_b32 v3, 0xffff0000, v81
    v_fmac_f32 v62, v2, v17
    v_fmac_f32 v63, v3, v17
    v_lshlrev_b32 v2, 16, v82
    v_and_b32 v3, 0xffff0000, v82
    v_fmac_f32 v64, v2, v17
    v_fmac_f32 v65, v3, v17
    v_lshlrev_b32 v2, 16, v83
    v_and_b32 v3, 0xffff0000, v83
    v_fmac_f32 v66, v2, v17
    v_fmac_f32 v67, v3, v17
    v_lshlrev_b32 v2, 16, v84
    v_and_b32 v3, 0xffff0000, v84
    v_fmac_f32 v60, v2, v18
    v_fmac_f32 v61, v3, v18
    v_lshlrev_b32 v2, 16, v85
    v_and_b32 v3, 0xffff0000, v85
    v_fmac_f32 v62, v2, v18
    v_fmac_f32 v63, v3, v18
    v_lshlrev_b32 v2, 16, v86
    v_and_b32 v3, 0xffff0000, v86
    v_fmac_f32 v64, v2, v18
    v_fmac_f32 v65, v3, v18
    v_lshlrev_b32 v2, 16, v87
    v_and_b32 v3, 0xffff0000, v87
    v_fmac_f32 v66, v2, v18
    v_fmac_f32 v67, v3, v18
    v_lshlrev_b32 v2, 16, v88
    v_and_b32 v3, 0xffff0000, v88
    v_fmac_f32 v60, v2, v19
    v_fmac_f32 v61, v3, v19
    v_lshlrev_b32 v2, 16, v89
    v_and_b32 v3, 0xffff0000, v89
    v_fmac_f32 v62, v2, v19
    v_fmac_f32 v63, v3, v19
    v_lshlrev_b32 v2, 16, v90
    v_and_b32 v3, 0xffff0000, v90
    v_fmac_f32 v64, v2, v19
    v_fmac_f32 v65, v3, v19
    v_lshlrev_b32 v2, 16, v91
    v_and_b32 v3, 0xffff0000, v91
    v_fmac_f32 v66, v2, v19
    v_fmac_f32 v67, v3, v19
    v_lshlrev_b32 v2, 16, v92
    v_and_b32 v3, 0xffff0000, v92
    v_fmac_f32 v60, v2, v20
    v_fmac_f32 v61, v3, v20
    v_lshlrev_b32 v2, 16, v93
    v_and_b32 v3, 0xffff0000, v93
    v_fmac_f32 v62, v2, v20
    v_fmac_f32 v63, v3, v20
    v_lshlrev_b32 v2, 16, v94
    v_and_b32 v3, 0xffff0000, v94
    v_fmac_f32 v64, v2, v20
    v_fmac_f32 v65, v3, v20
    v_lshlrev_b32 v2, 16, v95
    v_and_b32 v3, 0xffff0000, v95
    v_fmac_f32 v66, v2, v20
    v_fmac_f32 v67, v3, v20
    v_lshlrev_b32 v2, 16, v96
    v_and_b32 v3, 0xffff0000, v96
    v_fmac_f32 v60, v2, v21
    v_fmac_f32 v61, v3, v21
    v_lshlrev_b32 v2, 16, v97
    v_and_b32 v3, 0xffff0000, v97
    v_fmac_f32 v62, v2, v21
    v_fmac_f32 v63, v3, v21
    v_lshlrev_b32 v2, 16, v98
    v_and_b32 v3, 0xffff0000, v98
    v_fmac_f32 v64, v2, v21
    v_fmac_f32 v65, v3, v21
    v_lshlrev_b32 v2, 16, v99
    v_and_b32 v3, 0xffff0000, v99
    v_fmac_f32 v66, v2, v21
    v_fmac_f32 v67, v3, v21
    s_nop 1
    v_add_f32_dpp v60, v60, v60 row_ror:8 row_mask:0xf bank_mask:0xf
    v_add_f32_dpp v61, v61, v61 row_ror:8 row_mask:0xf bank_mask:0xf
    v_add_f32_dpp v62, v62, v62 row_ror:8 row_mask:0xf bank_mask:0xf
    v_add_f32_dpp v63, v63, v63 row_ror:8 row_mask:0xf bank_mask:0xf
    v_add_f32_dpp v64, v64, v64 row_ror:8 row_mask:0xf bank_mask:0xf
    v_add_f32_dpp v65, v65, v65 row_ror:8 row_mask:0xf bank_mask:0xf
    v_add_f32_dpp v66, v66, v66 row_ror:8 row_mask:0xf bank_mask:0xf
    v_add_f32_dpp v67, v67, v67 row_ror:8 row_mask:0xf bank_mask:0xf
    v_mov_b32 v28, v60
    v_mov_b32 v29, v61
    v_mov_b32 v30, v62
    v_mov_b32 v31, v63
    v_mov_b32 v32, v64
    v_mov_b32 v33, v65
    v_mov_b32 v34, v66
    v_mov_b32 v35, v67
    v_permlane32_swap_b32 v60, v28
    v_permlane32_swap_b32 v61, v29
    v_permlane32_swap_b32 v62, v30
    v_permlane32_swap_b32 v63, v31
    v_permlane32_swap_b32 v64, v32
    v_permlane32_swap_b32 v65, v33
    v_permlane32_swap_b32 v66, v34
    v_permlane32_swap_b32 v67, v35
    v_add_f32 v60, v60, v28
    v_add_f32 v61, v61, v29
    v_add_f32 v62, v62, v30
    v_add_f32 v63, v63, v31
    v_add_f32 v64, v64, v32
    v_add_f32 v65, v65, v33
    v_add_f32 v66, v66, v34
    v_add_f32 v67, v67, v35
    v_mov_b32 v28, v60
    v_mov_b32 v29, v61
    v_mov_b32 v30, v62
    v_mov_b32 v31, v63
    v_mov_b32 v32, v64
    v_mov_b32 v33, v65
    v_mov_b32 v34, v66
    v_mov_b32 v35, v67
    v_permlane16_swap_b32 v60, v28
    v_permlane16_swap_b32 v61, v29
    v_permlane16_swap_b32 v62, v30
    v_permlane16_swap_b32 v63, v31
    v_permlane16_swap_b32 v64, v32
    v_permlane16_swap_b32 v65, v33
    v_permlane16_swap_b32 v66, v34
    v_permlane16_swap_b32 v67, v35
    v_add_f32 v60, v60, v28
    v_add_f32 v61, v61, v29
    v_add_f32 v62, v62, v30
    v_add_f32 v63, v63, v31
    v_add_f32 v64, v64, v32
    v_add_f32 v65, v65, v33
    v_add_f32 v66, v66, v34
    v_add_f32 v67, v67, v35
    s_lshl_b32 s82, s89, 8
    v_lshlrev_b32 v2, 5, v1
    v_add_u32 v2, s82, v2
    s_mov_b64 exec, 0xff
    ds_write_b128 v2, v[60:63] offset:2624
    ds_write_b128 v2, v[64:67] offset:2640
    s_mov_b64 exec, -1
    s_waitcnt lgkmcnt(0)
    v_mov_b32 v4, 1
    s_mov_b64 exec, 1
    ds_add_u32 v253, v4 offset:4
    s_mov_b64 exec, -1
    s_branch L_xskip
L_w7x:
    s_mov_b32 s85, 2000000
L_sp22:
    ds_read_b32 v4, v253 offset:4
    s_waitcnt lgkmcnt(0)
    v_readfirstlane_b32 s82, v4
    s_cmp_ge_u32 s82, 3
    s_cbranch_scc1 L_spx23
    s_sub_u32 s85, s85, 1
    s_cmp_eq_u32 s85, 0
    s_cbranch_scc1 L_spx23
    s_sleep 0
    s_branch L_sp22
L_spx23:
    v_lshlrev_b32 v2, 2, v1
    ds_read_b32 v28, v2 offset:2624
    ds_read_b32 v29, v2 offset:2880
    ds_read_b32 v30, v2 offset:3136
    s_waitcnt vmcnt(0) lgkmcnt(0)
    s_cmp_eq_u32 s90, 0
    s_cselect_b32 s88, s88, s90
    v_add_f32 v28, v28, v29
    v_add_f32 v28, v28, v30
    v_mov_b32 v29, s88
    v_mov_b32 v254, s88
    s_lshl_b32 s84, s72, 13
    s_add_u32 s84, s84, 2363392
    s_lshl_b32 s82, s100, 11
    s_lshl_b32 s83, s101, 9
    s_add_u32 s82, s82, s83
    s_add_u32 s82, s82, s84
    v_lshlrev_b32 v2, 3, v1
    buffer_store_dwordx2 v[28:29], v2, s[60:63], s82 offen sc1
    v_lshlrev_b32 v2, 4, v1
    s_add_u32 s83, s84, 4096
    s_sleep 8
    s_mov_b32 s85, 65536
L_rt24:
    buffer_load_dwordx4 v[76:79], v2, s[60:63], s84 offen offset:0 sc1
    buffer_load_dwordx4 v[80:83], v2, s[60:63], s84 offen offset:1024 sc1
    buffer_load_dwordx4 v[84:87], v2, s[60:63], s84 offen offset:2048 sc1
    buffer_load_dwordx4 v[88:91], v2, s[60:63], s84 offen offset:3072 sc1
    buffer_load_dwordx4 v[92:95], v2, s[60:63], s83 offen offset:0 sc1
    buffer_load_dwordx4 v[96:99], v2, s[60:63], s83 offen offset:1024 sc1
    buffer_load_dwordx4 v[100:103], v2, s[60:63], s83 offen offset:2048 sc1
    buffer_load_dwordx4 v[104:107], v2, s[60:63], s83 offen offset:3072 sc1
    s_waitcnt vmcnt(0)
    v_xor_b32 v3, v254, v77
    v_xor_b32 v4, v254, v79
    v_or_b32 v3, v3, v4
    v_xor_b32 v4, v254, v81
    v_or_b32 v3, v3, v4
    v_xor_b32 v4, v254, v83
    v_or_b32 v3, v3, v4
    v_xor_b32 v4, v254, v85
    v_or_b32 v3, v3, v4
    v_xor_b32 v4, v254, v87
    v_or_b32 v3, v3, v4
    v_xor_b32 v4, v254, v89
    v_or_b32 v3, v3, v4
    v_xor_b32 v4, v254, v91
    v_or_b32 v3, v3, v4
    v_xor_b32 v4, v254, v93
    v_or_b32 v3, v3, v4
    v_xor_b32 v4, v254, v95
    v_or_b32 v3, v3, v4
    v_xor_b32 v4, v254, v97
    v_or_b32 v3, v3, v4
    v_xor_b32 v4, v254, v99
    v_or_b32 v3, v3, v4
    v_xor_b32 v4, v254, v101
    v_or_b32 v3, v3, v4
    v_xor_b32 v4, v254, v103
    v_or_b32 v3, v3, v4
    v_xor_b32 v4, v254, v105
    v_or_b32 v3, v3, v4
    v_xor_b32 v4, v254, v107
    v_or_b32 v3, v3, v4
    v_cmp_ne_u32 vcc, 0, v3
    s_cbranch_vccz L_rtx25
    s_sub_u32 s85, s85, 1
    s_cmp_eq_u32 s85, 0
    s_cbranch_scc1 L_rtx25
    s_sleep 2
    s_branch L_rt24
L_rtx25:
    v_add_f32 v76, v76, v84
    v_add_f32 v76, v76, v92
    v_add_f32 v76, v76, v100
    v_add_f32 v78, v78, v86
    v_add_f32 v78, v78, v94
    v_add_f32 v78, v78, v102
    v_cvt_pk_bf16_f32 v76, v76, v78
    v_add_f32 v80, v80, v88
    v_add_f32 v80, v80, v96
    v_add_f32 v80, v80, v104
    v_add_f32 v82, v82, v90
    v_add_f32 v82, v82, v98
    v_add_f32 v82, v82, v106
    v_cvt_pk_bf16_f32 v80, v80, v82
    v_lshlrev_b32 v2, 2, v1
    ds_write_b32 v2, v76 offset:3648
    ds_write_b32 v2, v80 offset:3904
    s_waitcnt lgkmcnt(0)
    ds_write_b32 v253, v254 offset:0
L_xskip:
    s_mov_b32 s76, s72
    s_mov_b32 s77, s73
    s_and_b32 s78, s2, 7
    s_lshl_b32 s78, s78, 5
    s_lshr_b32 s82, s2, 3
    s_or_b32 s78, s78, s82
    s_lshr_b32 s72, s78, 4
    s_and_b32 s73, s78, 15
    s_lshr_b32 s100, s73, 2
    s_and_b32 s101, s73, 3
    v_mul_u32_u24 v2, 57, v1
    v_lshrrev_b32 v2, 9, v2
    v_mul_u32_u24 v3, 9, v2
    v_sub_u32 v3, v1, v3
    s_mul_i32 s82, s101, 144
    s_mul_i32 s83, s89, 36
    s_add_u32 s82, s82, s83
    v_add_u32 v28, s82, v2
    s_mov_b32 s82, 9216
    v_mul_lo_u32 v29, v28, s82
    v_lshl_add_u32 v29, v3, 4, v29
    s_lshl_b32 s82, s72, 2
    s_add_u32 s82, s82, s100
    s_mul_i32 s82, s82, 144
    v_add_u32 v29, s82, v29
    v_mov_b32 v3, 0x7f000000
    v_cmp_gt_u32 vcc, 63, v1
    s_nop 1
    v_cndmask_b32 v29, v3, v29, vcc
    v_cmp_gt_u32 vcc, 9, v1
    s_nop 1
    v_cndmask_b32 v30, v3, v29, vcc
    s_mov_b32 s84, 0
    buffer_load_dwordx4 v[76:79], v29, s[44:47], s84 offen
    buffer_load_dwordx4 v[80:83], v29, s[48:51], s84 offen
    s_mov_b32 s84, 64512
    buffer_load_dwordx4 v[84:87], v29, s[44:47], s84 offen
    buffer_load_dwordx4 v[88:91], v29, s[48:51], s84 offen
    s_mov_b32 s84, 129024
    buffer_load_dwordx4 v[92:95], v29, s[44:47], s84 offen
    buffer_load_dwordx4 v[96:99], v29, s[48:51], s84 offen
    s_mov_b32 s84, 193536
    buffer_load_dwordx4 v[100:103], v29, s[44:47], s84 offen
    buffer_load_dwordx4 v[104:107], v29, s[48:51], s84 offen
    s_mov_b32 s84, 258048
    buffer_load_dwordx4 v[108:111], v29, s[44:47], s84 offen
    buffer_load_dwordx4 v[112:115], v29, s[48:51], s84 offen
    s_mov_b32 s84, 322560
    buffer_load_dwordx4 v[116:119], v30, s[44:47], s84 offen
    buffer_load_dwordx4 v[120:123], v30, s[48:51], s84 offen
    v_mul_u32_u24 v12, 57, v1
    v_lshrrev_b32 v12, 10, v12
    v_mul_u32_u24 v13, 18, v12
    v_sub_u32 v13, v1, v13
    s_mul_i32 s82, s89, 3
    v_add_u32 v12, s82, v12
    s_mov_b32 s82, 1152
    v_mul_lo_u32 v14, v12, s82
    v_lshl_add_u32 v14, v13, 4, v14
    s_mul_i32 s82, s101, 288
    v_add_u32 v14, s82, v14
    s_lshl_b32 s82, s72, 2
    s_add_u32 s82, s82, s100
    s_mul_i32 s84, s82, 73728
    s_mul_i32 s81, s82, 82944
    v_lshlrev_b32 v3, 2, v28
    ds_read_b32 v16, v3 offset:64
    ds_read_b32 v17, v3 offset:92
    ds_read_b32 v18, v3 offset:120
    ds_read_b32 v19, v3 offset:148
    ds_read_b32 v20, v3 offset:176
    ds_read_b32 v21, v3 offset:204
    s_waitcnt vmcnt(0) lgkmcnt(0)
    v_lshlrev_b32 v4, 16, v76
    v_and_b32 v5, 0xffff0000, v76
    v_mul_f32 v60, v4, v16
    v_mul_f32 v61, v5, v16
    v_lshlrev_b32 v4, 16, v77
    v_and_b32 v5, 0xffff0000, v77
    v_mul_f32 v62, v4, v16
    v_mul_f32 v63, v5, v16
    v_lshlrev_b32 v4, 16, v78
    v_and_b32 v5, 0xffff0000, v78
    v_mul_f32 v64, v4, v16
    v_mul_f32 v65, v5, v16
    v_lshlrev_b32 v4, 16, v79
    v_and_b32 v5, 0xffff0000, v79
    v_mul_f32 v66, v4, v16
    v_mul_f32 v67, v5, v16
    v_lshlrev_b32 v4, 16, v80
    v_and_b32 v5, 0xffff0000, v80
    v_mul_f32 v68, v4, v16
    v_mul_f32 v69, v5, v16
    v_lshlrev_b32 v4, 16, v81
    v_and_b32 v5, 0xffff0000, v81
    v_mul_f32 v70, v4, v16
    v_mul_f32 v71, v5, v16
    v_lshlrev_b32 v4, 16, v82
    v_and_b32 v5, 0xffff0000, v82
    v_mul_f32 v72, v4, v16
    v_mul_f32 v73, v5, v16
    v_lshlrev_b32 v4, 16, v83
    v_and_b32 v5, 0xffff0000, v83
    v_mul_f32 v74, v4, v16
    v_mul_f32 v75, v5, v16
    v_lshlrev_b32 v4, 16, v84
    v_and_b32 v5, 0xffff0000, v84
    v_fmac_f32 v60, v4, v17
    v_fmac_f32 v61, v5, v17
    v_lshlrev_b32 v4, 16, v85
    v_and_b32 v5, 0xffff0000, v85
    v_fmac_f32 v62, v4, v17
    v_fmac_f32 v63, v5, v17
    v_lshlrev_b32 v4, 16, v86
    v_and_b32 v5, 0xffff0000, v86
    v_fmac_f32 v64, v4, v17
    v_fmac_f32 v65, v5, v17
    v_lshlrev_b32 v4, 16, v87
    v_and_b32 v5, 0xffff0000, v87
    v_fmac_f32 v66, v4, v17
    v_fmac_f32 v67, v5, v17
    v_lshlrev_b32 v4, 16, v88
    v_and_b32 v5, 0xffff0000, v88
    v_fmac_f32 v68, v4, v17
    v_fmac_f32 v69, v5, v17
    v_lshlrev_b32 v4, 16, v89
    v_and_b32 v5, 0xffff0000, v89
    v_fmac_f32 v70, v4, v17
    v_fmac_f32 v71, v5, v17
    v_lshlrev_b32 v4, 16, v90
    v_and_b32 v5, 0xffff0000, v90
    v_fmac_f32 v72, v4, v17
    v_fmac_f32 v73, v5, v17
    v_lshlrev_b32 v4, 16, v91
    v_and_b32 v5, 0xffff0000, v91
    v_fmac_f32 v74, v4, v17
    v_fmac_f32 v75, v5, v17
    v_lshlrev_b32 v4, 16, v92
    v_and_b32 v5, 0xffff0000, v92
    v_fmac_f32 v60, v4, v18
    v_fmac_f32 v61, v5, v18
    v_lshlrev_b32 v4, 16, v93
    v_and_b32 v5, 0xffff0000, v93
    v_fmac_f32 v62, v4, v18
    v_fmac_f32 v63, v5, v18
    v_lshlrev_b32 v4, 16, v94
    v_and_b32 v5, 0xffff0000, v94
    v_fmac_f32 v64, v4, v18
    v_fmac_f32 v65, v5, v18
    v_lshlrev_b32 v4, 16, v95
    v_and_b32 v5, 0xffff0000, v95
    v_fmac_f32 v66, v4, v18
    v_fmac_f32 v67, v5, v18
    v_lshlrev_b32 v4, 16, v96
    v_and_b32 v5, 0xffff0000, v96
    v_fmac_f32 v68, v4, v18
    v_fmac_f32 v69, v5, v18
    v_lshlrev_b32 v4, 16, v97
    v_and_b32 v5, 0xffff0000, v97
    v_fmac_f32 v70, v4, v18
    v_fmac_f32 v71, v5, v18
    v_lshlrev_b32 v4, 16, v98
    v_and_b32 v5, 0xffff0000, v98
    v_fmac_f32 v72, v4, v18
    v_fmac_f32 v73, v5, v18
    v_lshlrev_b32 v4, 16, v99
    v_and_b32 v5, 0xffff0000, v99
    v_fmac_f32 v74, v4, v18
    v_fmac_f32 v75, v5, v18
    v_lshlrev_b32 v4, 16, v100
    v_and_b32 v5, 0xffff0000, v100
    v_fmac_f32 v60, v4, v19
    v_fmac_f32 v61, v5, v19
    v_lshlrev_b32 v4, 16, v101
    v_and_b32 v5, 0xffff0000, v101
    v_fmac_f32 v62, v4, v19
    v_fmac_f32 v63, v5, v19
    v_lshlrev_b32 v4, 16, v102
    v_and_b32 v5, 0xffff0000, v102
    v_fmac_f32 v64, v4, v19
    v_fmac_f32 v65, v5, v19
    v_lshlrev_b32 v4, 16, v103
    v_and_b32 v5, 0xffff0000, v103
    v_fmac_f32 v66, v4, v19
    v_fmac_f32 v67, v5, v19
    v_lshlrev_b32 v4, 16, v104
    v_and_b32 v5, 0xffff0000, v104
    v_fmac_f32 v68, v4, v19
    v_fmac_f32 v69, v5, v19
    v_lshlrev_b32 v4, 16, v105
    v_and_b32 v5, 0xffff0000, v105
    v_fmac_f32 v70, v4, v19
    v_fmac_f32 v71, v5, v19
    v_lshlrev_b32 v4, 16, v106
    v_and_b32 v5, 0xffff0000, v106
    v_fmac_f32 v72, v4, v19
    v_fmac_f32 v73, v5, v19
    v_lshlrev_b32 v4, 16, v107
    v_and_b32 v5, 0xffff0000, v107
    v_fmac_f32 v74, v4, v19
    v_fmac_f32 v75, v5, v19
    v_lshlrev_b32 v4, 16, v108
    v_and_b32 v5, 0xffff0000, v108
    v_fmac_f32 v60, v4, v20
    v_fmac_f32 v61, v5, v20
    v_lshlrev_b32 v4, 16, v109
    v_and_b32 v5, 0xffff0000, v109
    v_fmac_f32 v62, v4, v20
    v_fmac_f32 v63, v5, v20
    v_lshlrev_b32 v4, 16, v110
    v_and_b32 v5, 0xffff0000, v110
    v_fmac_f32 v64, v4, v20
    v_fmac_f32 v65, v5, v20
    v_lshlrev_b32 v4, 16, v111
    v_and_b32 v5, 0xffff0000, v111
    v_fmac_f32 v66, v4, v20
    v_fmac_f32 v67, v5, v20
    v_lshlrev_b32 v4, 16, v112
    v_and_b32 v5, 0xffff0000, v112
    v_fmac_f32 v68, v4, v20
    v_fmac_f32 v69, v5, v20
    v_lshlrev_b32 v4, 16, v113
    v_and_b32 v5, 0xffff0000, v113
    v_fmac_f32 v70, v4, v20
    v_fmac_f32 v71, v5, v20
    v_lshlrev_b32 v4, 16, v114
    v_and_b32 v5, 0xffff0000, v114
    v_fmac_f32 v72, v4, v20
    v_fmac_f32 v73, v5, v20
    v_lshlrev_b32 v4, 16, v115
    v_and_b32 v5, 0xffff0000, v115
    v_fmac_f32 v74, v4, v20
    v_fmac_f32 v75, v5, v20
    v_lshlrev_b32 v4, 16, v116
    v_and_b32 v5, 0xffff0000, v116
    v_fmac_f32 v60, v4, v21
    v_fmac_f32 v61, v5, v21
    v_lshlrev_b32 v4, 16, v117
    v_and_b32 v5, 0xffff0000, v117
    v_fmac_f32 v62, v4, v21
    v_fmac_f32 v63, v5, v21
    v_lshlrev_b32 v4, 16, v118
    v_and_b32 v5, 0xffff0000, v118
    v_fmac_f32 v64, v4, v21
    v_fmac_f32 v65, v5, v21
    v_lshlrev_b32 v4, 16, v119
    v_and_b32 v5, 0xffff0000, v119
    v_fmac_f32 v66, v4, v21
    v_fmac_f32 v67, v5, v21
    v_lshlrev_b32 v4, 16, v120
    v_and_b32 v5, 0xffff0000, v120
    v_fmac_f32 v68, v4, v21
    v_fmac_f32 v69, v5, v21
    v_lshlrev_b32 v4, 16, v121
    v_and_b32 v5, 0xffff0000, v121
    v_fmac_f32 v70, v4, v21
    v_fmac_f32 v71, v5, v21
    v_lshlrev_b32 v4, 16, v122
    v_and_b32 v5, 0xffff0000, v122
    v_fmac_f32 v72, v4, v21
    v_fmac_f32 v73, v5, v21
    v_lshlrev_b32 v4, 16, v123
    v_and_b32 v5, 0xffff0000, v123
    v_fmac_f32 v74, v4, v21
    v_fmac_f32 v75, v5, v21
    s_lshl_b32 s82, s89, 12
    v_lshlrev_b32 v2, 6, v1
    v_add_u32 v2, s82, v2
    ds_write_b128 v2, v[60:63] offset:4160
    ds_write_b128 v2, v[64:67] offset:4176
    ds_write_b128 v2, v[68:71] offset:4192
    ds_write_b128 v2, v[72:75] offset:4208
    s_waitcnt lgkmcnt(0)
    v_mov_b32 v4, 1
    s_mov_b64 exec, 1
    ds_add_rtn_u32 v4, v253, v4 offset:8
    s_waitcnt lgkmcnt(0)
    v_readfirstlane_b32 s82, v4
    s_mov_b64 exec, -1
    s_mov_b32 s80, s82
    s_mov_b32 s85, 1304347
L_sp26:
    ds_read_b32 v254, v253 offset:0
    s_waitcnt lgkmcnt(0)
    v_readfirstlane_b32 s82, v254
    s_cmp_ge_u32 s82, 1
    s_cbranch_scc1 L_spx27
    s_sub_u32 s85, s85, 1
    s_cmp_eq_u32 s85, 0
    s_cbranch_scc1 L_spx27
    s_sleep 1
    s_branch L_sp26
L_spx27:
    s_mov_b32 s88, s82
    s_cmp_lg_u32 s80, 3
    s_cbranch_scc1 L_fpskip
    v_lshrrev_b32 v2, 2, v1
    v_lshlrev_b32 v2, 6, v2
    v_and_b32 v3, 3, v1
    v_lshl_add_u32 v2, v3, 3, v2
    s_mov_b32 exec_hi, 0xf
    ds_read_b64 v[76:77], v2 offset:4160
    ds_read_b64 v[78:79], v2 offset:4736
    ds_read_b64 v[80:81], v2 offset:5312
    ds_read_b64 v[82:83], v2 offset:5888
    ds_read_b64 v[84:85], v2 offset:6464
    ds_read_b64 v[86:87], v2 offset:7040
    ds_read_b64 v[88:89], v2 offset:7616
    ds_read_b64 v[90:91], v2 offset:8256
    ds_read_b64 v[92:93], v2 offset:8832
    ds_read_b64 v[94:95], v2 offset:9408
    ds_read_b64 v[96:97], v2 offset:9984
    ds_read_b64 v[98:99], v2 offset:10560
    ds_read_b64 v[100:101], v2 offset:11136
    ds_read_b64 v[102:103], v2 offset:11712
    ds_read_b64 v[104:105], v2 offset:12352
    ds_read_b64 v[106:107], v2 offset:12928
    ds_read_b64 v[108:109], v2 offset:13504
    ds_read_b64 v[110:111], v2 offset:14080
    ds_read_b64 v[112:113], v2 offset:14656
    ds_read_b64 v[114:115], v2 offset:15232
    ds_read_b64 v[116:117], v2 offset:15808
    ds_read_b64 v[118:119], v2 offset:16448
    ds_read_b64 v[120:121], v2 offset:17024
    ds_read_b64 v[122:123], v2 offset:17600
    ds_read_b64 v[124:125], v2 offset:18176
    ds_read_b64 v[126:127], v2 offset:18752
    ds_read_b64 v[128:129], v2 offset:19328
    ds_read_b64 v[130:131], v2 offset:19904
    s_waitcnt lgkmcnt(0)
    v_add_f32 v60, v76, v78
    v_add_f32 v62, v77, v79
    v_add_f32 v60, v60, v80
    v_add_f32 v62, v62, v81
    v_add_f32 v60, v60, v82
    v_add_f32 v62, v62, v83
    v_add_f32 v60, v60, v84
    v_add_f32 v62, v62, v85
    v_add_f32 v60, v60, v86
    v_add_f32 v62, v62, v87
    v_add_f32 v60, v60, v88
    v_add_f32 v62, v62, v89
    v_add_f32 v60, v60, v90
    v_add_f32 v62, v62, v91
    v_add_f32 v60, v60, v92
    v_add_f32 v62, v62, v93
    v_add_f32 v60, v60, v94
    v_add_f32 v62, v62, v95
    v_add_f32 v60, v60, v96
    v_add_f32 v62, v62, v97
    v_add_f32 v60, v60, v98
    v_add_f32 v62, v62, v99
    v_add_f32 v60, v60, v100
    v_add_f32 v62, v62, v101
    v_add_f32 v60, v60, v102
    v_add_f32 v62, v62, v103
    v_add_f32 v60, v60, v104
    v_add_f32 v62, v62, v105
    v_add_f32 v60, v60, v106
    v_add_f32 v62, v62, v107
    v_add_f32 v60, v60, v108
    v_add_f32 v62, v62, v109
    v_add_f32 v60, v60, v110
    v_add_f32 v62, v62, v111
    v_add_f32 v60, v60, v112
    v_add_f32 v62, v62, v113
    v_add_f32 v60, v60, v114
    v_add_f32 v62, v62, v115
    v_add_f32 v60, v60, v116
    v_add_f32 v62, v62, v117
    v_add_f32 v60, v60, v118
    v_add_f32 v62, v62, v119
    v_add_f32 v60, v60, v120
    v_add_f32 v62, v62, v121
    v_add_f32 v60, v60, v122
    v_add_f32 v62, v62, v123
    v_add_f32 v60, v60, v124
    v_add_f32 v62, v62, v125
    v_add_f32 v60, v60, v126
    v_add_f32 v62, v62, v127
    v_add_f32 v60, v60, v128
    v_add_f32 v62, v62, v129
    v_add_f32 v60, v60, v130
    v_add_f32 v62, v62, v131
    v_mov_b32 v61, v254
    v_mov_b32 v63, v254
    ds_read_b64 v[76:77], v2 offset:4192
    ds_read_b64 v[78:79], v2 offset:4768
    ds_read_b64 v[80:81], v2 offset:5344
    ds_read_b64 v[82:83], v2 offset:5920
    ds_read_b64 v[84:85], v2 offset:6496
    ds_read_b64 v[86:87], v2 offset:7072
    ds_read_b64 v[88:89], v2 offset:7648
    ds_read_b64 v[90:91], v2 offset:8288
    ds_read_b64 v[92:93], v2 offset:8864
    ds_read_b64 v[94:95], v2 offset:9440
    ds_read_b64 v[96:97], v2 offset:10016
    ds_read_b64 v[98:99], v2 offset:10592
    ds_read_b64 v[100:101], v2 offset:11168
    ds_read_b64 v[102:103], v2 offset:11744
    ds_read_b64 v[104:105], v2 offset:12384
    ds_read_b64 v[106:107], v2 offset:12960
    ds_read_b64 v[108:109], v2 offset:13536
    ds_read_b64 v[110:111], v2 offset:14112
    ds_read_b64 v[112:113], v2 offset:14688
    ds_read_b64 v[114:115], v2 offset:15264
    ds_read_b64 v[116:117], v2 offset:15840
    ds_read_b64 v[118:119], v2 offset:16480
    ds_read_b64 v[120:121], v2 offset:17056
    ds_read_b64 v[122:123], v2 offset:17632
    ds_read_b64 v[124:125], v2 offset:18208
    ds_read_b64 v[126:127], v2 offset:18784
    ds_read_b64 v[128:129], v2 offset:19360
    ds_read_b64 v[130:131], v2 offset:19936
    s_waitcnt lgkmcnt(0)
    v_add_f32 v64, v76, v78
    v_add_f32 v66, v77, v79
    v_add_f32 v64, v64, v80
    v_add_f32 v66, v66, v81
    v_add_f32 v64, v64, v82
    v_add_f32 v66, v66, v83
    v_add_f32 v64, v64, v84
    v_add_f32 v66, v66, v85
    v_add_f32 v64, v64, v86
    v_add_f32 v66, v66, v87
    v_add_f32 v64, v64, v88
    v_add_f32 v66, v66, v89
    v_add_f32 v64, v64, v90
    v_add_f32 v66, v66, v91
    v_add_f32 v64, v64, v92
    v_add_f32 v66, v66, v93
    v_add_f32 v64, v64, v94
    v_add_f32 v66, v66, v95
    v_add_f32 v64, v64, v96
    v_add_f32 v66, v66, v97
    v_add_f32 v64, v64, v98
    v_add_f32 v66, v66, v99
    v_add_f32 v64, v64, v100
    v_add_f32 v66, v66, v101
    v_add_f32 v64, v64, v102
    v_add_f32 v66, v66, v103
    v_add_f32 v64, v64, v104
    v_add_f32 v66, v66, v105
    v_add_f32 v64, v64, v106
    v_add_f32 v66, v66, v107
    v_add_f32 v64, v64, v108
    v_add_f32 v66, v66, v109
    v_add_f32 v64, v64, v110
    v_add_f32 v66, v66, v111
    v_add_f32 v64, v64, v112
    v_add_f32 v66, v66, v113
    v_add_f32 v64, v64, v114
    v_add_f32 v66, v66, v115
    v_add_f32 v64, v64, v116
    v_add_f32 v66, v66, v117
    v_add_f32 v64, v64, v118
    v_add_f32 v66, v66, v119
    v_add_f32 v64, v64, v120
    v_add_f32 v66, v66, v121
    v_add_f32 v64, v64, v122
    v_add_f32 v66, v66, v123
    v_add_f32 v64, v64, v124
    v_add_f32 v66, v66, v125
    v_add_f32 v64, v64, v126
    v_add_f32 v66, v66, v127
    v_add_f32 v64, v64, v128
    v_add_f32 v66, v66, v129
    v_add_f32 v64, v64, v130
    v_add_f32 v66, v66, v131
    v_mov_b32 v65, v254
    v_mov_b32 v67, v254
    s_mul_i32 s84, s78, 1152
    s_add_u32 s84, s84, 557056
    v_lshlrev_b32 v2, 4, v1
    buffer_store_dwordx4 v[60:63], v2, s[60:63], s84 offen sc1
    buffer_store_dwordx4 v[64:67], v2, s[60:63], s84 offen offset:576 sc1
    s_mov_b64 exec, -1
L_fpskip:
    s_setprio 1
    s_cmp_lg_u32 s74, 4
    s_cbranch_scc1 L_rsskip
    s_and_b32 s82, s78, 0xfc
    s_mul_i32 s80, s82, 1152
    s_add_u32 s80, s80, 557056
    s_add_u32 s81, s80, 2304
    v_lshlrev_b32 v2, 4, v1
    s_mov_b32 s85, 110701
L_sp28:
    ds_read_b32 v4, v253 offset:40
    s_waitcnt lgkmcnt(0)
    v_readfirstlane_b32 s82, v4
    s_cmp_ge_u32 s82, 4
    s_cbranch_scc1 L_spx29
    s_sub_u32 s85, s85, 1
    s_cmp_eq_u32 s85, 0
    s_cbranch_scc1 L_spx29
    s_sleep 32
    s_branch L_sp28
L_spx29:
    s_mov_b32 exec_hi, 0xf
    s_mov_b32 s85, 65536
L_rt30:
    buffer_load_dwordx4 v[76:79], v2, s[60:63], s80 offen offset:0 sc1
    buffer_load_dwordx4 v[80:83], v2, s[60:63], s80 offen offset:576 sc1
    buffer_load_dwordx4 v[84:87], v2, s[60:63], s80 offen offset:1152 sc1
    buffer_load_dwordx4 v[88:91], v2, s[60:63], s80 offen offset:1728 sc1
    buffer_load_dwordx4 v[92:95], v2, s[60:63], s81 offen offset:0 sc1
    buffer_load_dwordx4 v[96:99], v2, s[60:63], s81 offen offset:576 sc1
    buffer_load_dwordx4 v[100:103], v2, s[60:63], s81 offen offset:1152 sc1
    buffer_load_dwordx4 v[104:107], v2, s[60:63], s81 offen offset:1728 sc1
    s_waitcnt vmcnt(0)
    v_xor_b32 v3, v254, v77
    v_xor_b32 v4, v254, v79
    v_or_b32 v3, v3, v4
    v_xor_b32 v4, v254, v81
    v_or_b32 v3, v3, v4
    v_xor_b32 v4, v254, v83
    v_or_b32 v3, v3, v4
    v_xor_b32 v4, v254, v85
    v_or_b32 v3, v3, v4
    v_xor_b32 v4, v254, v87
    v_or_b32 v3, v3, v4
    v_xor_b32 v4, v254, v89
    v_or_b32 v3, v3, v4
    v_xor_b32 v4, v254, v91
    v_or_b32 v3, v3, v4
    v_xor_b32 v4, v254, v93
    v_or_b32 v3, v3, v4
    v_xor_b32 v4, v254, v95
    v_or_b32 v3, v3, v4
    v_xor_b32 v4, v254, v97
    v_or_b32 v3, v3, v4
    v_xor_b32 v4, v254, v99
    v_or_b32 v3, v3, v4
    v_xor_b32 v4, v254, v101
    v_or_b32 v3, v3, v4
    v_xor_b32 v4, v254, v103
    v_or_b32 v3, v3, v4
    v_xor_b32 v4, v254, v105
    v_or_b32 v3, v3, v4
    v_xor_b32 v4, v254, v107
    v_or_b32 v3, v3, v4
    v_cmp_ne_u32 vcc, 0, v3
    s_cbranch_vccz L_rtx31
    s_sub_u32 s85, s85, 1
    s_cmp_eq_u32 s85, 0
    s_cbranch_scc1 L_rtx31
    s_sleep 32
    s_branch L_rt30
L_rtx31:
    v_add_f32 v76, v76, v84
    v_add_f32 v78, v78, v86
    v_add_f32 v80, v80, v88
    v_add_f32 v82, v82, v90
    v_add_f32 v76, v76, v92
    v_add_f32 v78, v78, v94
    v_add_f32 v80, v80, v96
    v_add_f32 v82, v82, v98
    v_add_f32 v76, v76, v100
    v_add_f32 v78, v78, v102
    v_add_f32 v80, v80, v104
    v_add_f32 v82, v82, v106
    v_cvt_pk_bf16_f32 v76, v76, v76
    v_lshlrev_b32 v76, 16, v76
    v_cvt_pk_bf16_f32 v78, v78, v78
    v_lshlrev_b32 v78, 16, v78
    v_cvt_pk_bf16_f32 v80, v80, v80
    v_lshlrev_b32 v80, 16, v80
    v_cvt_pk_bf16_f32 v82, v82, v82
    v_lshlrev_b32 v82, 16, v82
    v_mul_f32 v4, s79, v76
    v_exp_f32 v4, -v4
    s_nop 0
    v_add_f32 v4, 1.0, v4
    v_rcp_f32 v5, v4
    s_nop 0
    v_mul_f32 v6, v76, v5
    v_fma_f32 v7, -v6, v4, v76
    v_fma_f32 v76, v7, v5, v6
    v_cmp_eq_f32 vcc, 0x7f800000, v4
    s_nop 1
    v_cndmask_b32 v76, v76, v6, vcc
    v_cvt_pk_bf16_f32 v76, v76, v76
    v_lshlrev_b32 v76, 16, v76
    v_mul_f32 v76, v76, v80
    v_cvt_pk_bf16_f32 v76, v76, v76
    v_lshlrev_b32 v76, 16, v76
    v_mul_f32 v4, s79, v78
    v_exp_f32 v4, -v4
    s_nop 0
    v_add_f32 v4, 1.0, v4
    v_rcp_f32 v5, v4
    s_nop 0
    v_mul_f32 v6, v78, v5
    v_fma_f32 v7, -v6, v4, v78
    v_fma_f32 v78, v7, v5, v6
    v_cmp_eq_f32 vcc, 0x7f800000, v4
    s_nop 1
    v_cndmask_b32 v78, v78, v6, vcc
    v_cvt_pk_bf16_f32 v78, v78, v78
    v_lshlrev_b32 v78, 16, v78
    v_mul_f32 v78, v78, v82
    v_cvt_pk_bf16_f32 v78, v78, v78
    v_lshlrev_b32 v78, 16, v78
    v_mov_b32 v77, v78
    v_lshlrev_b32 v2, 3, v1
    ds_write_b64 v2, v[76:77] offset:25280
    s_mov_b64 exec, -1
    s_waitcnt lgkmcnt(0)
    v_mov_b32 v4, 1
    s_mov_b64 exec, 1
    ds_add_u32 v253, v4 offset:12
    s_mov_b64 exec, -1
L_rsskip:
    v_lshlrev_b32 v2, 2, v1
    ds_write_b32 v2, v253 offset:25024
    s_mov_b32 s85, 110701
L_sp32:
    ds_read_b32 v4, v253 offset:12
    s_waitcnt lgkmcnt(0)
    v_readfirstlane_b32 s82, v4
    s_cmp_ge_u32 s82, 1
    s_cbranch_scc1 L_spx33
    s_sub_u32 s85, s85, 1
    s_cmp_eq_u32 s85, 0
    s_cbranch_scc1 L_spx33
    s_sleep 32
    s_branch L_sp32
L_spx33:
    s_mul_i32 s82, s73, 72
    v_lshlrev_b32 v206, 1, v1
    v_add_u32 v206, s82, v206
    buffer_load_ushort v207, v206, s[36:39], 0 offen
    s_cmp_lg_u32 s74, 6
    s_cbranch_scc1 L_rbskip
    s_mov_b32 s85, 638297
L_sp34:
    ds_read_b32 v4, v253 offset:56
    s_waitcnt lgkmcnt(0)
    v_readfirstlane_b32 s82, v4
    s_cmp_ge_u32 s82, 1
    s_cbranch_scc1 L_spx35
    s_sub_u32 s85, s85, 1
    s_cmp_eq_u32 s85, 0
    s_cbranch_scc1 L_spx35
    s_sleep 4
    s_branch L_sp34
L_spx35:
    s_sub_u32 s82, s82, s88
    v_mov_b32 v76, s82
    v_mov_b32 v77, v254
    s_lshl_b32 s84, s76, 7
    s_add_u32 s84, s84, 2494464
    s_lshl_b32 s82, s77, 3
    s_add_u32 s82, s82, s84
    s_mov_b64 exec, 1
    buffer_store_dwordx2 v[76:77], v253, s[60:63], s82 offen sc1
    s_mov_b64 exec, -1
    s_mov_b32 s85, 379746
L_sp36:
    ds_read_b32 v4, v253 offset:40
    s_waitcnt lgkmcnt(0)
    v_readfirstlane_b32 s82, v4
    s_cmp_ge_u32 s82, 16
    s_cbranch_scc1 L_spx37
    s_sub_u32 s85, s85, 1
    s_cmp_eq_u32 s85, 0
    s_cbranch_scc1 L_spx37
    s_sleep 8
    s_branch L_sp36
L_spx37:
    v_lshlrev_b32 v2, 3, v1
    s_mov_b64 exec, 0xffff
    s_mov_b32 s85, 65536
L_rt38:
    buffer_load_dwordx2 v[76:77], v2, s[60:63], s84 offen sc1
    s_waitcnt vmcnt(0)
    v_xor_b32 v3, v254, v77
    v_cmp_ne_u32 vcc, 0, v3
    s_cbranch_vccz L_rtx39
    s_sub_u32 s85, s85, 1
    s_cmp_eq_u32 s85, 0
    s_cbranch_scc1 L_rtx39
    s_sleep 16
    s_branch L_rt38
L_rtx39:
    v_cvt_f32_u32 v78, v76
    v_rcp_f32 v78, v78
    s_nop 0
    v_mov_b32 v79, v78
    s_nop 1
    v_add_f32_dpp v79, v79, v79 quad_perm:[1,0,3,2] row_mask:0xf bank_mask:0xf
    s_nop 1
    v_add_f32_dpp v79, v79, v79 quad_perm:[2,3,0,1] row_mask:0xf bank_mask:0xf
    s_nop 1
    v_add_f32_dpp v79, v79, v79 row_half_mirror row_mask:0xf bank_mask:0xf
    s_nop 1
    v_add_f32_dpp v79, v79, v79 row_mirror row_mask:0xf bank_mask:0xf
    v_rcp_f32 v79, v79
    s_nop 0
    v_mul_f32 v78, v78, v79
    v_mul_f32 v78, 0x44f00000, v78
    v_add_f32 v78, 0xc2e00000, v78
    v_max_f32 v78, 0, v78
    s_nop 1
    v_add_f32_dpp v78, v78, v78 row_shr:1 row_mask:0xf bank_mask:0xf bound_ctrl:0
    s_nop 1
    v_add_f32_dpp v78, v78, v78 row_shr:2 row_mask:0xf bank_mask:0xf bound_ctrl:0
    s_nop 1
    v_add_f32_dpp v78, v78, v78 row_shr:4 row_mask:0xf bank_mask:0xf bound_ctrl:0
    s_nop 1
    v_add_f32_dpp v78, v78, v78 row_shr:8 row_mask:0xf bank_mask:0xf bound_ctrl:0
    s_nop 0
    v_readlane_b32 s82, v78, 15
    s_nop 1
    v_mov_b32 v79, s82
    v_rcp_f32 v79, v79
    s_nop 0
    v_mul_f32 v78, v78, v79
    v_mul_f32 v78, 0x43000000, v78
    v_add_f32 v78, 0.5, v78
    v_cvt_u32_f32 v78, v78
    v_min_u32 v78, 128, v78
    s_mov_b64 exec, -1
    s_nop 0
    s_mov_b32 m0, s77
    v_readlane_b32 s81, v78, m0
    s_cmp_eq_u32 s77, 15
    s_cselect_b32 s81, 128, s81
    s_sub_u32 s82, s77, 1
    s_max_i32 s82, s82, 0
    s_mov_b32 m0, s82
    v_readlane_b32 s80, v78, m0
    s_cmp_eq_u32 s77, 0
    s_cselect_b32 s80, 0, s80
    s_add_u32 s81, s81, 1
    v_mov_b32 v76, s80
    v_mov_b32 v77, s81
    ds_write_b64 v253, v[76:77] offset:48
L_rbskip:
    s_mov_b32 s85, 638297
L_sp40:
    ds_read_b32 v4, v253 offset:20
    s_waitcnt lgkmcnt(0)
    v_readfirstlane_b32 s82, v4
    s_cmp_ge_u32 s82, 1
    s_cbranch_scc1 L_spx41
    s_sub_u32 s85, s85, 1
    s_cmp_eq_u32 s85, 0
    s_cbranch_scc1 L_spx41
    s_sleep 4
    s_branch L_sp40
L_spx41:
    s_cmp_eq_u32 s89, 0
    s_cbranch_scc1 L_wd42
    v_subrev_u32 v204, 3, v12
    v_subrev_u32 v205, 3456, v14
    s_lshl_b32 s82, s72, 2
    s_add_u32 s82, s82, s100
    s_mul_i32 s84, s82, 82944
    v_mov_b32 v172, 0
    v_mov_b32 v173, 0
    v_mov_b32 v174, 0
    v_mov_b32 v175, 0
    v_mov_b32 v176, 0
    v_mov_b32 v177, 0
    v_mov_b32 v178, 0
    v_mov_b32 v179, 0
    v_mov_b32 v180, 0
    v_mov_b32 v181, 0
    v_mov_b32 v182, 0
    v_mov_b32 v183, 0
    v_mov_b32 v184, 0
    v_mov_b32 v185, 0
    v_mov_b32 v186, 0
    v_mov_b32 v187, 0
    v_mov_b32 v188, 0
    v_mov_b32 v189, 0
    v_mov_b32 v190, 0
    v_mov_b32 v191, 0
    v_mov_b32 v192, 0
    v_mov_b32 v193, 0
    v_mov_b32 v194, 0
    v_mov_b32 v195, 0
    v_mov_b32 v196, 0
    v_mov_b32 v197, 0
    v_mov_b32 v198, 0
    v_mov_b32 v199, 0
    v_mov_b32 v200, 0
    v_mov_b32 v201, 0
    v_mov_b32 v202, 0
    v_mov_b32 v203, 0
    s_mov_b32 exec_hi, 0x3fffff
    buffer_load_dwordx4 v[172:175], v205, s[56:59], s84 offen
    s_add_u32 s84, s84, 10368
    buffer_load_dwordx4 v[176:179], v205, s[56:59], s84 offen
    s_add_u32 s84, s84, 10368
    buffer_load_dwordx4 v[180:183], v205, s[56:59], s84 offen
    s_add_u32 s84, s84, 10368
    buffer_load_dwordx4 v[184:187], v205, s[56:59], s84 offen
    s_add_u32 s84, s84, 10368
    buffer_load_dwordx4 v[188:191], v205, s[56:59], s84 offen
    s_add_u32 s84, s84, 10368
    buffer_load_dwordx4 v[192:195], v205, s[56:59], s84 offen
    s_add_u32 s84, s84, 10368
    buffer_load_dwordx4 v[196:199], v205, s[56:59], s84 offen
    s_add_u32 s84, s84, 10368
    buffer_load_dwordx4 v[200:203], v205, s[56:59], s84 offen
    s_add_u32 s84, s84, 10368
    s_mov_b64 exec, -1
L_wd42:
    s_lshl_b32 s82, s72, 2
    s_add_u32 s82, s82, s100
    s_mul_i32 s84, s82, 73728
    v_add_u32 v3, 0, v12
    v_cmp_gt_u32 vcc, 64, v3
    s_mov_b32 s86, -1
    s_mov_b32 s87, 0x3fffff
    s_and_b64 vcc, vcc, s[86:87]
    v_mov_b32 v148, 0
    v_mov_b32 v149, 0
    v_mov_b32 v150, 0
    v_mov_b32 v151, 0
    s_mov_b64 exec, vcc
    s_cbranch_execz L_w2s43
    buffer_load_dwordx4 v[148:151], v14, s[52:55], s84 offen
L_w2s43:
    s_mov_b64 exec, -1
    s_add_u32 s84, s84, 13824
    v_add_u32 v3, 12, v12
    v_cmp_gt_u32 vcc, 64, v3
    s_mov_b32 s86, -1
    s_mov_b32 s87, 0x3fffff
    s_and_b64 vcc, vcc, s[86:87]
    v_mov_b32 v152, 0
    v_mov_b32 v153, 0
    v_mov_b32 v154, 0
    v_mov_b32 v155, 0
    s_mov_b64 exec, vcc
    s_cbranch_execz L_w2s44
    buffer_load_dwordx4 v[152:155], v14, s[52:55], s84 offen
L_w2s44:
    s_mov_b64 exec, -1
    s_add_u32 s84, s84, 13824
    v_add_u32 v3, 24, v12
    v_cmp_gt_u32 vcc, 64, v3
    s_mov_b32 s86, -1
    s_mov_b32 s87, 0x3fffff
    s_and_b64 vcc, vcc, s[86:87]
    v_mov_b32 v156, 0
    v_mov_b32 v157, 0
    v_mov_b32 v158, 0
    v_mov_b32 v159, 0
    s_mov_b64 exec, vcc
    s_cbranch_execz L_w2s45
    buffer_load_dwordx4 v[156:159], v14, s[52:55], s84 offen
L_w2s45:
    s_mov_b64 exec, -1
    s_add_u32 s84, s84, 13824
    v_add_u32 v3, 36, v12
    v_cmp_gt_u32 vcc, 64, v3
    s_mov_b32 s86, -1
    s_mov_b32 s87, 0x3fffff
    s_and_b64 vcc, vcc, s[86:87]
    v_mov_b32 v160, 0
    v_mov_b32 v161, 0
    v_mov_b32 v162, 0
    v_mov_b32 v163, 0
    s_mov_b64 exec, vcc
    s_cbranch_execz L_w2s46
    buffer_load_dwordx4 v[160:163], v14, s[52:55], s84 offen
L_w2s46:
    s_mov_b64 exec, -1
    s_add_u32 s84, s84, 13824
    v_add_u32 v3, 48, v12
    v_cmp_gt_u32 vcc, 64, v3
    s_mov_b32 s86, -1
    s_mov_b32 s87, 0x3fffff
    s_and_b64 vcc, vcc, s[86:87]
    v_mov_b32 v164, 0
    v_mov_b32 v165, 0
    v_mov_b32 v166, 0
    v_mov_b32 v167, 0
    s_mov_b64 exec, vcc
    s_cbranch_execz L_w2s47
    buffer_load_dwordx4 v[164:167], v14, s[52:55], s84 offen
L_w2s47:
    s_mov_b64 exec, -1
    s_add_u32 s84, s84, 13824
    v_add_u32 v3, 60, v12
    v_cmp_gt_u32 vcc, 64, v3
    s_mov_b32 s86, -1
    s_mov_b32 s87, 0x3fffff
    s_and_b64 vcc, vcc, s[86:87]
    v_mov_b32 v168, 0
    v_mov_b32 v169, 0
    v_mov_b32 v170, 0
    v_mov_b32 v171, 0
    s_mov_b64 exec, vcc
    s_cbranch_execz L_w2s48
    buffer_load_dwordx4 v[168:171], v14, s[52:55], s84 offen
L_w2s48:
    s_mov_b64 exec, -1
    s_add_u32 s84, s84, 13824
    s_mov_b32 s85, 1304347
L_sp49:
    ds_read_b32 v4, v253 offset:20
    s_waitcnt lgkmcnt(0)
    v_readfirstlane_b32 s82, v4
    s_cmp_ge_u32 s82, 4
    s_cbranch_scc1 L_spx50
    s_sub_u32 s85, s85, 1
    s_cmp_eq_u32 s85, 0
    s_cbranch_scc1 L_spx50
    s_sleep 1
    s_branch L_sp49
L_spx50:
    s_setprio 3
    v_and_b32 v7, 255, v0
    v_lshlrev_b32 v2, 2, v7
    v_lshrrev_b32 v3, 7, v7
    v_lshlrev_b32 v3, 2, v3
    ds_read_b32 v76, v3 offset:21568
    ds_read_b32 v80, v3 offset:21576
    ds_read_b32 v84, v2 offset:20544
    ds_read_b32 v77, v3 offset:22624
    ds_read_b32 v81, v3 offset:22632
    ds_read_b32 v85, v2 offset:21600
    ds_read_b32 v78, v3 offset:23680
    ds_read_b32 v82, v3 offset:23688
    ds_read_b32 v86, v2 offset:22656
    ds_read_b32 v79, v3 offset:24736
    ds_read_b32 v83, v3 offset:24744
    ds_read_b32 v87, v2 offset:23712
    s_waitcnt lgkmcnt(0)
    v_max3_f32 v68, v76, v77, v78
    v_max_f32 v68, v68, v79
    v_sub_f32 v76, v76, v68
    v_sub_f32 v77, v77, v68
    v_sub_f32 v78, v78, v68
    v_sub_f32 v79, v79, v68
    v_exp_f32 v76, v76
    v_exp_f32 v77, v77
    v_exp_f32 v78, v78
    v_exp_f32 v79, v79
    s_nop 0
    v_mul_f32 v70, v76, v80
    v_mul_f32 v72, v76, v84
    v_fmac_f32 v70, v77, v81
    v_fmac_f32 v72, v77, v85
    v_fmac_f32 v70, v78, v82
    v_fmac_f32 v72, v78, v86
    v_fmac_f32 v70, v79, v83
    v_fmac_f32 v72, v79, v87
    v_mov_b32 v69, v254
    v_mov_b32 v71, v254
    v_mov_b32 v73, v254
    s_mul_i32 s84, s75, 2176
    v_lshlrev_b32 v2, 3, v7
    buffer_store_dwordx2 v[72:73], v2, s[60:63], s84 offen sc1
    v_lshlrev_b32 v3, 2, v3
    s_and_b32 s82, s89, 1
    s_cmp_lg_u32 s82, 0
    s_cbranch_scc1 L_mlskip
    s_mov_b64 exec, 1
    buffer_store_dwordx4 v[68:71], v3, s[60:63], s84 offen offset:2048 sc1
    s_mov_b64 exec, -1
L_mlskip:
    s_cmp_lg_u32 s74, 4
    s_cbranch_scc1 L_ypath
    v_and_b32 v2, 15, v1
    v_mul_u32_u24 v2, 2176, v2
    s_lshr_b32 s82, s100, 1
    s_lshl_b32 s82, s82, 4
    s_mul_i32 s80, s72, 34816
    s_add_u32 s81, s80, s82
    s_mov_b64 exec, 0xffff
    s_mov_b32 s85, 65536
L_rt51:
    buffer_load_dwordx4 v[76:79], v2, s[60:63], s81 offen offset:2048 sc1
    s_waitcnt vmcnt(0)
    v_cmp_eq_u32 vcc, v254, v77
    s_bcnt1_i32_b64 s82, vcc
    s_cmp_ge_u32 s82, 15
    s_cbranch_scc1 L_rtx52
    s_sub_u32 s85, s85, 1
    s_cmp_eq_u32 s85, 0
    s_cbranch_scc1 L_rtx52
    s_sleep 8
    s_branch L_rt51
L_rtx52:
    s_mov_b64 exec, -1
    s_lshl_b32 s82, s100, 9
    s_add_u32 s80, s80, s82
    v_lshlrev_b32 v5, 3, v1
    s_mov_b32 s85, 65536
L_rt53:
    buffer_load_dwordx4 v[76:79], v2, s[60:63], s81 offen offset:2048 sc1
    s_mov_b32 s84, s80
    buffer_load_dwordx2 v[84:85], v5, s[60:63], s84 offen sc1
    s_add_u32 s84, s84, 2176
    buffer_load_dwordx2 v[86:87], v5, s[60:63], s84 offen sc1
    s_add_u32 s84, s84, 2176
    buffer_load_dwordx2 v[88:89], v5, s[60:63], s84 offen sc1
    s_add_u32 s84, s84, 2176
    buffer_load_dwordx2 v[90:91], v5, s[60:63], s84 offen sc1
    s_add_u32 s84, s84, 2176
    buffer_load_dwordx2 v[92:93], v5, s[60:63], s84 offen sc1
    s_add_u32 s84, s84, 2176
    buffer_load_dwordx2 v[94:95], v5, s[60:63], s84 offen sc1
    s_add_u32 s84, s84, 2176
    buffer_load_dwordx2 v[96:97], v5, s[60:63], s84 offen sc1
    s_add_u32 s84, s84, 2176
    buffer_load_dwordx2 v[98:99], v5, s[60:63], s84 offen sc1
    s_add_u32 s84, s84, 2176
    buffer_load_dwordx2 v[100:101], v5, s[60:63], s84 offen sc1
    s_add_u32 s84, s84, 2176
    buffer_load_dwordx2 v[102:103], v5, s[60:63], s84 offen sc1
    s_add_u32 s84, s84, 2176
    buffer_load_dwordx2 v[104:105], v5, s[60:63], s84 offen sc1
    s_add_u32 s84, s84, 2176
    buffer_load_dwordx2 v[106:107], v5, s[60:63], s84 offen sc1
    s_add_u32 s84, s84, 2176
    buffer_load_dwordx2 v[108:109], v5, s[60:63], s84 offen sc1
    s_add_u32 s84, s84, 2176
    buffer_load_dwordx2 v[110:111], v5, s[60:63], s84 offen sc1
    s_add_u32 s84, s84, 2176
    buffer_load_dwordx2 v[112:113], v5, s[60:63], s84 offen sc1
    s_add_u32 s84, s84, 2176
    buffer_load_dwordx2 v[114:115], v5, s[60:63], s84 offen sc1
    s_add_u32 s84, s84, 2176
    s_waitcnt vmcnt(0)
    v_xor_b32 v3, v254, v77
    v_xor_b32 v4, v254, v79
    v_or_b32 v3, v3, v4
    v_xor_b32 v4, v254, v85
    v_or_b32 v3, v3, v4
    v_xor_b32 v4, v254, v87
    v_or_b32 v3, v3, v4
    v_xor_b32 v4, v254, v89
    v_or_b32 v3, v3, v4
    v_xor_b32 v4, v254, v91
    v_or_b32 v3, v3, v4
    v_xor_b32 v4, v254, v93
    v_or_b32 v3, v3, v4
    v_xor_b32 v4, v254, v95
    v_or_b32 v3, v3, v4
    v_xor_b32 v4, v254, v97
    v_or_b32 v3, v3, v4
    v_xor_b32 v4, v254, v99
    v_or_b32 v3, v3, v4
    v_xor_b32 v4, v254, v101
    v_or_b32 v3, v3, v4
    v_xor_b32 v4, v254, v103
    v_or_b32 v3, v3, v4
    v_xor_b32 v4, v254, v105
    v_or_b32 v3, v3, v4
    v_xor_b32 v4, v254, v107
    v_or_b32 v3, v3, v4
    v_xor_b32 v4, v254, v109
    v_or_b32 v3, v3, v4
    v_xor_b32 v4, v254, v111
    v_or_b32 v3, v3, v4
    v_xor_b32 v4, v254, v113
    v_or_b32 v3, v3, v4
    v_xor_b32 v4, v254, v115
    v_or_b32 v3, v3, v4
    v_cmp_ne_u32 vcc, 0, v3
    s_cbranch_vccz L_rtx54
    s_sub_u32 s85, s85, 1
    s_cmp_eq_u32 s85, 0
    s_cbranch_scc1 L_rtx54
    s_sleep 2
    s_branch L_rt53
L_rtx54:
    v_mov_b32 v80, v76
    s_nop 1
    v_max_f32_dpp v80, v80, v80 quad_perm:[1,0,3,2] row_mask:0xf bank_mask:0xf
    s_nop 1
    v_max_f32_dpp v80, v80, v80 quad_perm:[2,3,0,1] row_mask:0xf bank_mask:0xf
    s_nop 1
    v_max_f32_dpp v80, v80, v80 row_half_mirror row_mask:0xf bank_mask:0xf
    s_nop 1
    v_max_f32_dpp v80, v80, v80 row_mirror row_mask:0xf bank_mask:0xf
    v_sub_f32 v76, v76, v80
    v_exp_f32 v76, v76
    s_nop 0
    v_mul_f32 v81, v76, v78
    s_nop 1
    v_add_f32_dpp v81, v81, v81 quad_perm:[1,0,3,2] row_mask:0xf bank_mask:0xf
    s_nop 1
    v_add_f32_dpp v81, v81, v81 quad_perm:[2,3,0,1] row_mask:0xf bank_mask:0xf
    s_nop 1
    v_add_f32_dpp v81, v81, v81 row_half_mirror row_mask:0xf bank_mask:0xf
    s_nop 1
    v_add_f32_dpp v81, v81, v81 row_mirror row_mask:0xf bank_mask:0xf
    s_nop 0
    v_readlane_b32 s81, v81, 0
    v_readlane_b32 s82, v76, 0
    s_nop 1
    v_mul_f32 v72, s82, v84
    v_readlane_b32 s82, v76, 1
    s_nop 1
    v_fmac_f32 v72, s82, v86
    v_readlane_b32 s82, v76, 2
    s_nop 1
    v_fmac_f32 v72, s82, v88
    v_readlane_b32 s82, v76, 3
    s_nop 1
    v_fmac_f32 v72, s82, v90
    v_readlane_b32 s82, v76, 4
    s_nop 1
    v_fmac_f32 v72, s82, v92
    v_readlane_b32 s82, v76, 5
    s_nop 1
    v_fmac_f32 v72, s82, v94
    v_readlane_b32 s82, v76, 6
    s_nop 1
    v_fmac_f32 v72, s82, v96
    v_readlane_b32 s82, v76, 7
    s_nop 1
    v_fmac_f32 v72, s82, v98
    v_readlane_b32 s82, v76, 8
    s_nop 1
    v_fmac_f32 v72, s82, v100
    v_readlane_b32 s82, v76, 9
    s_nop 1
    v_fmac_f32 v72, s82, v102
    v_readlane_b32 s82, v76, 10
    s_nop 1
    v_fmac_f32 v72, s82, v104
    v_readlane_b32 s82, v76, 11
    s_nop 1
    v_fmac_f32 v72, s82, v106
    v_readlane_b32 s82, v76, 12
    s_nop 1
    v_fmac_f32 v72, s82, v108
    v_readlane_b32 s82, v76, 13
    s_nop 1
    v_fmac_f32 v72, s82, v110
    v_readlane_b32 s82, v76, 14
    s_nop 1
    v_fmac_f32 v72, s82, v112
    v_readlane_b32 s82, v76, 15
    s_nop 1
    v_fmac_f32 v72, s82, v114
    v_mov_b32 v70, s81
    v_rcp_f32 v5, v70
    s_nop 0
    v_mul_f32 v6, v72, v5
    v_fma_f32 v7, -v6, v70, v72
    v_fma_f32 v72, v7, v5, v6
    v_cvt_pk_bf16_f32 v72, v72, v72
    v_lshlrev_b32 v72, 16, v72
    v_lshlrev_b32 v2, 2, v1
    ds_write_b32 v2, v72 offset:24768
    s_waitcnt lgkmcnt(0)
    v_mov_b32 v4, 1
    s_mov_b64 exec, 1
    ds_add_u32 v253, v4 offset:24
    s_mov_b64 exec, -1
    s_branch L_l1skip
L_ypath:
    s_waitcnt vmcnt(0)
    v_lshlrev_b32 v2, 2, v204
    ds_read_b32 v16, v2 offset:25280
    ds_read_b32 v17, v2 offset:25316
    ds_read_b32 v18, v2 offset:25352
    ds_read_b32 v19, v2 offset:25388
    ds_read_b32 v20, v2 offset:25424
    ds_read_b32 v21, v2 offset:25460
    ds_read_b32 v22, v2 offset:25496
    ds_read_b32 v23, v2 offset:25532
    s_waitcnt lgkmcnt(0)
    v_lshlrev_b32 v4, 16, v172
    v_and_b32 v5, 0xffff0000, v172
    v_mul_f32 v60, v4, v16
    v_mul_f32 v61, v5, v16
    v_lshlrev_b32 v4, 16, v173
    v_and_b32 v5, 0xffff0000, v173
    v_mul_f32 v62, v4, v16
    v_mul_f32 v63, v5, v16
    v_lshlrev_b32 v4, 16, v174
    v_and_b32 v5, 0xffff0000, v174
    v_mul_f32 v64, v4, v16
    v_mul_f32 v65, v5, v16
    v_lshlrev_b32 v4, 16, v175
    v_and_b32 v5, 0xffff0000, v175
    v_mul_f32 v66, v4, v16
    v_mul_f32 v67, v5, v16
    v_lshlrev_b32 v4, 16, v176
    v_and_b32 v5, 0xffff0000, v176
    v_fmac_f32 v60, v4, v17
    v_fmac_f32 v61, v5, v17
    v_lshlrev_b32 v4, 16, v177
    v_and_b32 v5, 0xffff0000, v177
    v_fmac_f32 v62, v4, v17
    v_fmac_f32 v63, v5, v17
    v_lshlrev_b32 v4, 16, v178
    v_and_b32 v5, 0xffff0000, v178
    v_fmac_f32 v64, v4, v17
    v_fmac_f32 v65, v5, v17
    v_lshlrev_b32 v4, 16, v179
    v_and_b32 v5, 0xffff0000, v179
    v_fmac_f32 v66, v4, v17
    v_fmac_f32 v67, v5, v17
    v_lshlrev_b32 v4, 16, v180
    v_and_b32 v5, 0xffff0000, v180
    v_fmac_f32 v60, v4, v18
    v_fmac_f32 v61, v5, v18
    v_lshlrev_b32 v4, 16, v181
    v_and_b32 v5, 0xffff0000, v181
    v_fmac_f32 v62, v4, v18
    v_fmac_f32 v63, v5, v18
    v_lshlrev_b32 v4, 16, v182
    v_and_b32 v5, 0xffff0000, v182
    v_fmac_f32 v64, v4, v18
    v_fmac_f32 v65, v5, v18
    v_lshlrev_b32 v4, 16, v183
    v_and_b32 v5, 0xffff0000, v183
    v_fmac_f32 v66, v4, v18
    v_fmac_f32 v67, v5, v18
    v_lshlrev_b32 v4, 16, v184
    v_and_b32 v5, 0xffff0000, v184
    v_fmac_f32 v60, v4, v19
    v_fmac_f32 v61, v5, v19
    v_lshlrev_b32 v4, 16, v185
    v_and_b32 v5, 0xffff0000, v185
    v_fmac_f32 v62, v4, v19
    v_fmac_f32 v63, v5, v19
    v_lshlrev_b32 v4, 16, v186
    v_and_b32 v5, 0xffff0000, v186
    v_fmac_f32 v64, v4, v19
    v_fmac_f32 v65, v5, v19
    v_lshlrev_b32 v4, 16, v187
    v_and_b32 v5, 0xffff0000, v187
    v_fmac_f32 v66, v4, v19
    v_fmac_f32 v67, v5, v19
    v_lshlrev_b32 v4, 16, v188
    v_and_b32 v5, 0xffff0000, v188
    v_fmac_f32 v60, v4, v20
    v_fmac_f32 v61, v5, v20
    v_lshlrev_b32 v4, 16, v189
    v_and_b32 v5, 0xffff0000, v189
    v_fmac_f32 v62, v4, v20
    v_fmac_f32 v63, v5, v20
    v_lshlrev_b32 v4, 16, v190
    v_and_b32 v5, 0xffff0000, v190
    v_fmac_f32 v64, v4, v20
    v_fmac_f32 v65, v5, v20
    v_lshlrev_b32 v4, 16, v191
    v_and_b32 v5, 0xffff0000, v191
    v_fmac_f32 v66, v4, v20
    v_fmac_f32 v67, v5, v20
    v_lshlrev_b32 v4, 16, v192
    v_and_b32 v5, 0xffff0000, v192
    v_fmac_f32 v60, v4, v21
    v_fmac_f32 v61, v5, v21
    v_lshlrev_b32 v4, 16, v193
    v_and_b32 v5, 0xffff0000, v193
    v_fmac_f32 v62, v4, v21
    v_fmac_f32 v63, v5, v21
    v_lshlrev_b32 v4, 16, v194
    v_and_b32 v5, 0xffff0000, v194
    v_fmac_f32 v64, v4, v21
    v_fmac_f32 v65, v5, v21
    v_lshlrev_b32 v4, 16, v195
    v_and_b32 v5, 0xffff0000, v195
    v_fmac_f32 v66, v4, v21
    v_fmac_f32 v67, v5, v21
    v_lshlrev_b32 v4, 16, v196
    v_and_b32 v5, 0xffff0000, v196
    v_fmac_f32 v60, v4, v22
    v_fmac_f32 v61, v5, v22
    v_lshlrev_b32 v4, 16, v197
    v_and_b32 v5, 0xffff0000, v197
    v_fmac_f32 v62, v4, v22
    v_fmac_f32 v63, v5, v22
    v_lshlrev_b32 v4, 16, v198
    v_and_b32 v5, 0xffff0000, v198
    v_fmac_f32 v64, v4, v22
    v_fmac_f32 v65, v5, v22
    v_lshlrev_b32 v4, 16, v199
    v_and_b32 v5, 0xffff0000, v199
    v_fmac_f32 v66, v4, v22
    v_fmac_f32 v67, v5, v22
    v_lshlrev_b32 v4, 16, v200
    v_and_b32 v5, 0xffff0000, v200
    v_fmac_f32 v60, v4, v23
    v_fmac_f32 v61, v5, v23
    v_lshlrev_b32 v4, 16, v201
    v_and_b32 v5, 0xffff0000, v201
    v_fmac_f32 v62, v4, v23
    v_fmac_f32 v63, v5, v23
    v_lshlrev_b32 v4, 16, v202
    v_and_b32 v5, 0xffff0000, v202
    v_fmac_f32 v64, v4, v23
    v_fmac_f32 v65, v5, v23
    v_lshlrev_b32 v4, 16, v203
    v_and_b32 v5, 0xffff0000, v203
    v_fmac_f32 v66, v4, v23
    v_fmac_f32 v67, v5, v23
    s_lshl_b32 s82, s89, 11
    v_lshlrev_b32 v2, 5, v1
    v_add_u32 v2, s82, v2
    ds_write_b128 v2, v[60:63] offset:33984
    ds_write_b128 v2, v[64:67] offset:34000
    s_waitcnt lgkmcnt(0)
    v_mov_b32 v4, 1
    s_mov_b64 exec, 1
    ds_add_rtn_u32 v4, v253, v4 offset:16
    s_waitcnt lgkmcnt(0)
    v_readfirstlane_b32 s82, v4
    s_mov_b64 exec, -1
    s_cmp_lg_u32 s82, 2
    s_cbranch_scc1 L_sm55
    v_lshlrev_b32 v2, 2, v1
    ds_read_b32 v76, v2 offset:36032
    ds_read_b32 v77, v2 offset:36608
    ds_read_b32 v78, v2 offset:37184
    ds_read_b32 v79, v2 offset:38080
    ds_read_b32 v80, v2 offset:38656
    ds_read_b32 v81, v2 offset:39232
    ds_read_b32 v82, v2 offset:40128
    ds_read_b32 v83, v2 offset:40704
    ds_read_b32 v84, v2 offset:41280
    ds_read_b32 v88, v2 offset:36288
    ds_read_b32 v89, v2 offset:36864
    ds_read_b32 v90, v2 offset:37440
    ds_read_b32 v91, v2 offset:38336
    ds_read_b32 v92, v2 offset:38912
    ds_read_b32 v93, v2 offset:39488
    ds_read_b32 v94, v2 offset:40384
    ds_read_b32 v95, v2 offset:40960
    ds_read_b32 v96, v2 offset:41536
    ds_read_b32 v100, v2 offset:36544
    ds_read_b32 v101, v2 offset:37120
    ds_read_b32 v102, v2 offset:37696
    ds_read_b32 v103, v2 offset:38592
    ds_read_b32 v104, v2 offset:39168
    ds_read_b32 v105, v2 offset:39744
    ds_read_b32 v106, v2 offset:40640
    ds_read_b32 v107, v2 offset:41216
    ds_read_b32 v108, v2 offset:41792
    s_lshl_b32 s82, s72, 2
    s_add_u32 s82, s82, s100
    s_lshl_b32 s84, s101, 6
    s_add_u32 s84, s84, s82
    s_mul_i32 s84, s84, 1152
    s_add_u32 s84, s84, 2068480
    v_lshlrev_b32 v2, 3, v1
    s_waitcnt lgkmcnt(0)
    v_add_f32 v76, v76, v77
    v_add_f32 v76, v76, v78
    v_add_f32 v76, v76, v79
    v_add_f32 v76, v76, v80
    v_add_f32 v76, v76, v81
    v_add_f32 v76, v76, v82
    v_add_f32 v76, v76, v83
    v_add_f32 v76, v76, v84
    v_mov_b32 v77, v254
    buffer_store_dwordx2 v[76:77], v2, s[60:63], s84 offen offset:0 sc1
    v_add_f32 v88, v88, v89
    v_add_f32 v88, v88, v90
    v_add_f32 v88, v88, v91
    v_add_f32 v88, v88, v92
    v_add_f32 v88, v88, v93
    v_add_f32 v88, v88, v94
    v_add_f32 v88, v88, v95
    v_add_f32 v88, v88, v96
    v_mov_b32 v89, v254
    buffer_store_dwordx2 v[88:89], v2, s[60:63], s84 offen offset:512 sc1
    v_add_f32 v100, v100, v101
    v_add_f32 v100, v100, v102
    v_add_f32 v100, v100, v103
    v_add_f32 v100, v100, v104
    v_add_f32 v100, v100, v105
    v_add_f32 v100, v100, v106
    v_add_f32 v100, v100, v107
    v_add_f32 v100, v100, v108
    v_mov_b32 v101, v254
    s_mov_b64 exec, 0xffff
    buffer_store_dwordx2 v[100:101], v2, s[60:63], s84 offen offset:1024 sc1
    s_mov_b64 exec, -1
L_sm55:
L_l1skip:
    s_mov_b32 s85, 2000000
L_sp56:
    ds_read_b32 v4, v253 offset:24
    s_waitcnt lgkmcnt(0)
    v_readfirstlane_b32 s82, v4
    s_cmp_ge_u32 s82, 1
    s_cbranch_scc1 L_spx57
    s_sub_u32 s85, s85, 1
    s_cmp_eq_u32 s85, 0
    s_cbranch_scc1 L_spx57
    s_sleep 0
    s_branch L_sp56
L_spx57:
    s_waitcnt vmcnt(0)
    v_lshlrev_b32 v2, 2, v12
    ds_read_b32 v16, v2 offset:24768
    ds_read_b32 v17, v2 offset:24816
    ds_read_b32 v18, v2 offset:24864
    ds_read_b32 v19, v2 offset:24912
    ds_read_b32 v20, v2 offset:24960
    ds_read_b32 v21, v2 offset:25008
    s_waitcnt lgkmcnt(0)
    v_lshlrev_b32 v4, 16, v148
    v_and_b32 v5, 0xffff0000, v148
    v_mul_f32 v60, v4, v16
    v_mul_f32 v61, v5, v16
    v_lshlrev_b32 v4, 16, v149
    v_and_b32 v5, 0xffff0000, v149
    v_mul_f32 v62, v4, v16
    v_mul_f32 v63, v5, v16
    v_lshlrev_b32 v4, 16, v150
    v_and_b32 v5, 0xffff0000, v150
    v_mul_f32 v64, v4, v16
    v_mul_f32 v65, v5, v16
    v_lshlrev_b32 v4, 16, v151
    v_and_b32 v5, 0xffff0000, v151
    v_mul_f32 v66, v4, v16
    v_mul_f32 v67, v5, v16
    v_lshlrev_b32 v4, 16, v152
    v_and_b32 v5, 0xffff0000, v152
    v_fmac_f32 v60, v4, v17
    v_fmac_f32 v61, v5, v17
    v_lshlrev_b32 v4, 16, v153
    v_and_b32 v5, 0xffff0000, v153
    v_fmac_f32 v62, v4, v17
    v_fmac_f32 v63, v5, v17
    v_lshlrev_b32 v4, 16, v154
    v_and_b32 v5, 0xffff0000, v154
    v_fmac_f32 v64, v4, v17
    v_fmac_f32 v65, v5, v17
    v_lshlrev_b32 v4, 16, v155
    v_and_b32 v5, 0xffff0000, v155
    v_fmac_f32 v66, v4, v17
    v_fmac_f32 v67, v5, v17
    v_lshlrev_b32 v4, 16, v156
    v_and_b32 v5, 0xffff0000, v156
    v_fmac_f32 v60, v4, v18
    v_fmac_f32 v61, v5, v18
    v_lshlrev_b32 v4, 16, v157
    v_and_b32 v5, 0xffff0000, v157
    v_fmac_f32 v62, v4, v18
    v_fmac_f32 v63, v5, v18
    v_lshlrev_b32 v4, 16, v158
    v_and_b32 v5, 0xffff0000, v158
    v_fmac_f32 v64, v4, v18
    v_fmac_f32 v65, v5, v18
    v_lshlrev_b32 v4, 16, v159
    v_and_b32 v5, 0xffff0000, v159
    v_fmac_f32 v66, v4, v18
    v_fmac_f32 v67, v5, v18
    v_lshlrev_b32 v4, 16, v160
    v_and_b32 v5, 0xffff0000, v160
    v_fmac_f32 v60, v4, v19
    v_fmac_f32 v61, v5, v19
    v_lshlrev_b32 v4, 16, v161
    v_and_b32 v5, 0xffff0000, v161
    v_fmac_f32 v62, v4, v19
    v_fmac_f32 v63, v5, v19
    v_lshlrev_b32 v4, 16, v162
    v_and_b32 v5, 0xffff0000, v162
    v_fmac_f32 v64, v4, v19
    v_fmac_f32 v65, v5, v19
    v_lshlrev_b32 v4, 16, v163
    v_and_b32 v5, 0xffff0000, v163
    v_fmac_f32 v66, v4, v19
    v_fmac_f32 v67, v5, v19
    v_lshlrev_b32 v4, 16, v164
    v_and_b32 v5, 0xffff0000, v164
    v_fmac_f32 v60, v4, v20
    v_fmac_f32 v61, v5, v20
    v_lshlrev_b32 v4, 16, v165
    v_and_b32 v5, 0xffff0000, v165
    v_fmac_f32 v62, v4, v20
    v_fmac_f32 v63, v5, v20
    v_lshlrev_b32 v4, 16, v166
    v_and_b32 v5, 0xffff0000, v166
    v_fmac_f32 v64, v4, v20
    v_fmac_f32 v65, v5, v20
    v_lshlrev_b32 v4, 16, v167
    v_and_b32 v5, 0xffff0000, v167
    v_fmac_f32 v66, v4, v20
    v_fmac_f32 v67, v5, v20
    v_lshlrev_b32 v4, 16, v168
    v_and_b32 v5, 0xffff0000, v168
    v_fmac_f32 v60, v4, v21
    v_fmac_f32 v61, v5, v21
    v_lshlrev_b32 v4, 16, v169
    v_and_b32 v5, 0xffff0000, v169
    v_fmac_f32 v62, v4, v21
    v_fmac_f32 v63, v5, v21
    v_lshlrev_b32 v4, 16, v170
    v_and_b32 v5, 0xffff0000, v170
    v_fmac_f32 v64, v4, v21
    v_fmac_f32 v65, v5, v21
    v_lshlrev_b32 v4, 16, v171
    v_and_b32 v5, 0xffff0000, v171
    v_fmac_f32 v66, v4, v21
    v_fmac_f32 v67, v5, v21
    s_lshl_b32 s82, s89, 11
    v_lshlrev_b32 v2, 5, v1
    v_add_u32 v2, s82, v2
    ds_write_b128 v2, v[60:63] offset:25792
    ds_write_b128 v2, v[64:67] offset:25808
    s_waitcnt lgkmcnt(0)
    v_mov_b32 v4, 1
    s_mov_b64 exec, 1
    ds_add_rtn_u32 v4, v253, v4 offset:28
    s_waitcnt lgkmcnt(0)
    v_readfirstlane_b32 s82, v4
    s_mov_b64 exec, -1
    s_cmp_lg_u32 s82, 3
    s_cbranch_scc1 L_sm58
    v_lshlrev_b32 v2, 2, v1
    ds_read_b32 v76, v2 offset:25792
    ds_read_b32 v77, v2 offset:26368
    ds_read_b32 v78, v2 offset:26944
    ds_read_b32 v79, v2 offset:27840
    ds_read_b32 v80, v2 offset:28416
    ds_read_b32 v81, v2 offset:28992
    ds_read_b32 v82, v2 offset:29888
    ds_read_b32 v83, v2 offset:30464
    ds_read_b32 v84, v2 offset:31040
    ds_read_b32 v85, v2 offset:31936
    ds_read_b32 v86, v2 offset:32512
    ds_read_b32 v87, v2 offset:33088
    ds_read_b32 v88, v2 offset:26048
    ds_read_b32 v89, v2 offset:26624
    ds_read_b32 v90, v2 offset:27200
    ds_read_b32 v91, v2 offset:28096
    ds_read_b32 v92, v2 offset:28672
    ds_read_b32 v93, v2 offset:29248
    ds_read_b32 v94, v2 offset:30144
    ds_read_b32 v95, v2 offset:30720
    ds_read_b32 v96, v2 offset:31296
    ds_read_b32 v97, v2 offset:32192
    ds_read_b32 v98, v2 offset:32768
    ds_read_b32 v99, v2 offset:33344
    ds_read_b32 v100, v2 offset:26304
    ds_read_b32 v101, v2 offset:26880
    ds_read_b32 v102, v2 offset:27456
    ds_read_b32 v103, v2 offset:28352
    ds_read_b32 v104, v2 offset:28928
    ds_read_b32 v105, v2 offset:29504
    ds_read_b32 v106, v2 offset:30400
    ds_read_b32 v107, v2 offset:30976
    ds_read_b32 v108, v2 offset:31552
    ds_read_b32 v109, v2 offset:32448
    ds_read_b32 v110, v2 offset:33024
    ds_read_b32 v111, v2 offset:33600
    s_lshl_b32 s82, s72, 2
    s_add_u32 s82, s82, s100
    s_lshl_b32 s84, s101, 6
    s_add_u32 s84, s84, s82
    s_mul_i32 s84, s84, 1152
    s_add_u32 s84, s84, 1773568
    v_lshlrev_b32 v2, 3, v1
    s_waitcnt lgkmcnt(0)
    v_add_f32 v76, v76, v77
    v_add_f32 v76, v76, v78
    v_add_f32 v76, v76, v79
    v_add_f32 v76, v76, v80
    v_add_f32 v76, v76, v81
    v_add_f32 v76, v76, v82
    v_add_f32 v76, v76, v83
    v_add_f32 v76, v76, v84
    v_add_f32 v76, v76, v85
    v_add_f32 v76, v76, v86
    v_add_f32 v76, v76, v87
    v_mov_b32 v77, v254
    buffer_store_dwordx2 v[76:77], v2, s[60:63], s84 offen offset:0 sc1
    v_add_f32 v88, v88, v89
    v_add_f32 v88, v88, v90
    v_add_f32 v88, v88, v91
    v_add_f32 v88, v88, v92
    v_add_f32 v88, v88, v93
    v_add_f32 v88, v88, v94
    v_add_f32 v88, v88, v95
    v_add_f32 v88, v88, v96
    v_add_f32 v88, v88, v97
    v_add_f32 v88, v88, v98
    v_add_f32 v88, v88, v99
    v_mov_b32 v89, v254
    buffer_store_dwordx2 v[88:89], v2, s[60:63], s84 offen offset:512 sc1
    v_add_f32 v100, v100, v101
    v_add_f32 v100, v100, v102
    v_add_f32 v100, v100, v103
    v_add_f32 v100, v100, v104
    v_add_f32 v100, v100, v105
    v_add_f32 v100, v100, v106
    v_add_f32 v100, v100, v107
    v_add_f32 v100, v100, v108
    v_add_f32 v100, v100, v109
    v_add_f32 v100, v100, v110
    v_add_f32 v100, v100, v111
    v_mov_b32 v101, v254
    s_mov_b64 exec, 0xffff
    buffer_store_dwordx2 v[100:101], v2, s[60:63], s84 offen offset:1024 sc1
    s_mov_b64 exec, -1
L_sm58:
    s_cmp_lg_u32 s72, s73
    s_cbranch_scc1 L_end
    s_mul_i32 s82, s89, 3
    v_subrev_u32 v6, s82, v12
    s_mov_b32 s82, 1152
    v_mul_lo_u32 v2, v6, s82
    v_lshl_add_u32 v2, v13, 4, v2
    s_lshr_b32 s82, s73, 2
    s_lshl_b32 s82, s82, 6
    s_lshl_b32 s83, s89, 4
    s_add_u32 s82, s82, s83
    s_mul_i32 s80, s82, 1152
    s_and_b32 s82, s73, 3
    s_mul_i32 s82, s82, 288
    s_add_u32 s80, s80, s82
    s_add_u32 s80, s80, 2068480
    v_mov_b32 v96, 0
    v_mov_b32 v97, v254
    v_mov_b32 v98, 0
    v_mov_b32 v99, v254
    s_mov_b32 exec_hi, 0x3fffff
    s_mov_b32 s85, 65536
L_rt59:
    s_add_u32 s84, s80, 0
    buffer_load_dwordx4 v[76:79], v2, s[60:63], s84 offen sc1
    s_add_u32 s84, s84, 3456
    buffer_load_dwordx4 v[80:83], v2, s[60:63], s84 offen sc1
    s_add_u32 s84, s84, 3456
    buffer_load_dwordx4 v[84:87], v2, s[60:63], s84 offen sc1
    s_add_u32 s84, s84, 3456
    buffer_load_dwordx4 v[88:91], v2, s[60:63], s84 offen sc1
    s_add_u32 s84, s84, 3456
    buffer_load_dwordx4 v[92:95], v2, s[60:63], s84 offen sc1
    s_add_u32 s84, s84, 3456
    s_mov_b64 exec, 0x3ffff
    buffer_load_dwordx4 v[96:99], v2, s[60:63], s84 offen sc1
    s_add_u32 s84, s84, 3456
    s_mov_b32 exec_lo, -1
    s_mov_b32 exec_hi, 0x3fffff
    s_waitcnt vmcnt(0)
    v_xor_b32 v3, v254, v77
    v_xor_b32 v4, v254, v79
    v_or_b32 v3, v3, v4
    v_xor_b32 v4, v254, v81
    v_or_b32 v3, v3, v4
    v_xor_b32 v4, v254, v83
    v_or_b32 v3, v3, v4
    v_xor_b32 v4, v254, v85
    v_or_b32 v3, v3, v4
    v_xor_b32 v4, v254, v87
    v_or_b32 v3, v3, v4
    v_xor_b32 v4, v254, v89
    v_or_b32 v3, v3, v4
    v_xor_b32 v4, v254, v91
    v_or_b32 v3, v3, v4
    v_xor_b32 v4, v254, v93
    v_or_b32 v3, v3, v4
    v_xor_b32 v4, v254, v95
    v_or_b32 v3, v3, v4
    v_xor_b32 v4, v254, v97
    v_or_b32 v3, v3, v4
    v_xor_b32 v4, v254, v99
    v_or_b32 v3, v3, v4
    v_cmp_ne_u32 vcc, 0, v3
    s_cbranch_vccz L_rtx60
    s_sub_u32 s85, s85, 1
    s_cmp_eq_u32 s85, 0
    s_cbranch_scc1 L_rtx60
    s_sleep 1
    s_branch L_rt59
L_rtx60:
    s_lshl_b32 s82, s89, 9
    v_lshlrev_b32 v2, 3, v1
    v_add_u32 v2, s82, v2
    v_add_f32 v76, v76, v80
    v_add_f32 v78, v78, v82
    v_add_f32 v76, v76, v84
    v_add_f32 v78, v78, v86
    v_add_f32 v76, v76, v88
    v_add_f32 v78, v78, v90
    v_add_f32 v76, v76, v92
    v_add_f32 v78, v78, v94
    v_add_f32 v76, v76, v96
    v_add_f32 v78, v78, v98
    v_mov_b32 v77, v78
    ds_write_b64 v2, v[76:77] offset:44224
    s_mov_b64 exec, -1
    s_waitcnt lgkmcnt(0)
    v_mov_b32 v4, 1
    s_mov_b64 exec, 1
    ds_add_rtn_u32 v4, v253, v4 offset:32
    s_waitcnt lgkmcnt(0)
    v_readfirstlane_b32 s82, v4
    s_mov_b64 exec, -1
    s_mul_i32 s82, s89, 3
    v_subrev_u32 v6, s82, v12
    s_mov_b32 s82, 1152
    v_mul_lo_u32 v2, v6, s82
    v_lshl_add_u32 v2, v13, 4, v2
    s_lshr_b32 s82, s73, 2
    s_lshl_b32 s82, s82, 6
    s_lshl_b32 s83, s89, 4
    s_add_u32 s82, s82, s83
    s_mul_i32 s80, s82, 1152
    s_and_b32 s82, s73, 3
    s_mul_i32 s82, s82, 288
    s_add_u32 s80, s80, s82
    s_add_u32 s80, s80, 1773568
    v_mov_b32 v96, 0
    v_mov_b32 v97, v254
    v_mov_b32 v98, 0
    v_mov_b32 v99, v254
    s_mov_b32 exec_hi, 0x3fffff
    s_mov_b32 s85, 65536
L_rt61:
    s_add_u32 s84, s80, 0
    buffer_load_dwordx4 v[76:79], v2, s[60:63], s84 offen sc1
    s_add_u32 s84, s84, 3456
    buffer_load_dwordx4 v[80:83], v2, s[60:63], s84 offen sc1
    s_add_u32 s84, s84, 3456
    buffer_load_dwordx4 v[84:87], v2, s[60:63], s84 offen sc1
    s_add_u32 s84, s84, 3456
    buffer_load_dwordx4 v[88:91], v2, s[60:63], s84 offen sc1
    s_add_u32 s84, s84, 3456
    buffer_load_dwordx4 v[92:95], v2, s[60:63], s84 offen sc1
    s_add_u32 s84, s84, 3456
    s_mov_b64 exec, 0x3ffff
    buffer_load_dwordx4 v[96:99], v2, s[60:63], s84 offen sc1
    s_add_u32 s84, s84, 3456
    s_mov_b32 exec_lo, -1
    s_mov_b32 exec_hi, 0x3fffff
    s_waitcnt vmcnt(0)
    v_xor_b32 v3, v254, v77
    v_xor_b32 v4, v254, v79
    v_or_b32 v3, v3, v4
    v_xor_b32 v4, v254, v81
    v_or_b32 v3, v3, v4
    v_xor_b32 v4, v254, v83
    v_or_b32 v3, v3, v4
    v_xor_b32 v4, v254, v85
    v_or_b32 v3, v3, v4
    v_xor_b32 v4, v254, v87
    v_or_b32 v3, v3, v4
    v_xor_b32 v4, v254, v89
    v_or_b32 v3, v3, v4
    v_xor_b32 v4, v254, v91
    v_or_b32 v3, v3, v4
    v_xor_b32 v4, v254, v93
    v_or_b32 v3, v3, v4
    v_xor_b32 v4, v254, v95
    v_or_b32 v3, v3, v4
    v_xor_b32 v4, v254, v97
    v_or_b32 v3, v3, v4
    v_xor_b32 v4, v254, v99
    v_or_b32 v3, v3, v4
    v_cmp_ne_u32 vcc, 0, v3
    s_cbranch_vccz L_rtx62
    s_sub_u32 s85, s85, 1
    s_cmp_eq_u32 s85, 0
    s_cbranch_scc1 L_rtx62
    s_sleep 1
    s_branch L_rt61
L_rtx62:
    s_lshl_b32 s82, s89, 9
    v_lshlrev_b32 v2, 3, v1
    v_add_u32 v2, s82, v2
    v_add_f32 v76, v76, v80
    v_add_f32 v78, v78, v82
    v_add_f32 v76, v76, v84
    v_add_f32 v78, v78, v86
    v_add_f32 v76, v76, v88
    v_add_f32 v78, v78, v90
    v_add_f32 v76, v76, v92
    v_add_f32 v78, v78, v94
    v_add_f32 v76, v76, v96
    v_add_f32 v78, v78, v98
    v_mov_b32 v77, v78
    ds_write_b64 v2, v[76:77] offset:42176
    s_mov_b64 exec, -1
    s_waitcnt lgkmcnt(0)
    v_mov_b32 v4, 1
    s_mov_b64 exec, 1
    ds_add_rtn_u32 v4, v253, v4 offset:36
    s_waitcnt lgkmcnt(0)
    v_readfirstlane_b32 s82, v4
    s_mov_b64 exec, -1
    s_cmp_lg_u32 s82, 3
    s_cbranch_scc1 L_end
    s_mul_i32 s82, s73, 72
    v_lshlrev_b32 v8, 1, v1
    v_add_u32 v8, s82, v8
    s_mov_b32 exec_hi, 0xf
    v_lshlrev_b32 v2, 2, v1
    ds_read_b32 v76, v2 offset:42176
    ds_read_b32 v77, v2 offset:42320
    ds_read_b32 v78, v2 offset:42464
    ds_read_b32 v79, v2 offset:42688
    ds_read_b32 v80, v2 offset:42832
    ds_read_b32 v81, v2 offset:42976
    ds_read_b32 v82, v2 offset:43200
    ds_read_b32 v83, v2 offset:43344
    ds_read_b32 v84, v2 offset:43488
    ds_read_b32 v85, v2 offset:43712
    ds_read_b32 v86, v2 offset:43856
    ds_read_b32 v87, v2 offset:44000
    ds_read_b32 v88, v2 offset:44224
    ds_read_b32 v89, v2 offset:44368
    ds_read_b32 v90, v2 offset:44512
    ds_read_b32 v91, v2 offset:44736
    ds_read_b32 v92, v2 offset:44880
    ds_read_b32 v93, v2 offset:45024
    ds_read_b32 v94, v2 offset:45248
    ds_read_b32 v95, v2 offset:45392
    ds_read_b32 v96, v2 offset:45536
    ds_read_b32 v97, v2 offset:45760
    ds_read_b32 v98, v2 offset:45904
    ds_read_b32 v99, v2 offset:46048
    s_waitcnt lgkmcnt(0)
    v_add_f32 v88, v88, v89
    v_add_f32 v88, v88, v90
    v_add_f32 v88, v88, v91
    v_add_f32 v88, v88, v92
    v_add_f32 v88, v88, v93
    v_add_f32 v88, v88, v94
    v_add_f32 v88, v88, v95
    v_add_f32 v88, v88, v96
    v_add_f32 v88, v88, v97
    v_add_f32 v88, v88, v98
    v_add_f32 v88, v88, v99
    v_cvt_pk_bf16_f32 v88, v88, v88
    v_lshlrev_b32 v88, 16, v88
    v_mul_f32 v4, s79, v88
    v_exp_f32 v4, -v4
    s_nop 0
    v_add_f32 v4, 1.0, v4
    v_rcp_f32 v5, v4
    s_nop 0
    v_mul_f32 v6, v88, v5
    v_fma_f32 v7, -v6, v4, v88
    v_fma_f32 v88, v7, v5, v6
    v_cmp_eq_f32 vcc, 0x7f800000, v4
    s_nop 1
    v_cndmask_b32 v88, v88, v6, vcc
    v_cvt_pk_bf16_f32 v88, v88, v88
    v_lshlrev_b32 v88, 16, v88
    v_lshlrev_b32 v89, 16, v207
    v_add_f32 v76, v76, v77
    v_add_f32 v76, v76, v78
    v_add_f32 v76, v76, v79
    v_add_f32 v76, v76, v80
    v_add_f32 v76, v76, v81
    v_add_f32 v76, v76, v82
    v_add_f32 v76, v76, v83
    v_add_f32 v76, v76, v84
    v_add_f32 v76, v76, v85
    v_add_f32 v76, v76, v86
    v_add_f32 v76, v76, v87
    v_cvt_pk_bf16_f32 v76, v76, v76
    v_lshlrev_b32 v76, 16, v76
    v_mul_f32 v76, v76, v88
    v_cvt_pk_bf16_f32 v76, v76, v76
    v_lshlrev_b32 v76, 16, v76
    v_add_f32 v76, v76, v89
    v_cvt_pk_bf16_f32 v76, v76, v76
    buffer_store_short v76, v8, s[64:67], 0 offen
    s_mov_b64 exec, 1
    buffer_store_dword v253, v253, s[68:71], 0 offen sc1
L_end:
L_exit:
    s_endpgm
.section .rodata,"a"
.p2align 6
.amdhsa_kernel recurrent_scan__gqa_block_cached__swiglu_ffn__decode_kernel
  .amdhsa_next_free_vgpr 256
  .amdhsa_next_free_sgpr 102
  .amdhsa_accum_offset 256
  .amdhsa_group_segment_fixed_size 0
  .amdhsa_kernarg_size 96
  .amdhsa_user_sgpr_count 2
  .amdhsa_user_sgpr_kernarg_segment_ptr 1
  .amdhsa_system_sgpr_workgroup_id_x 1
  .amdhsa_float_denorm_mode_32 3
.end_amdhsa_kernel
```
